```python
import torch

def _softmax(x, axis=-1):
    return torch.softmax(x, dim=axis)
def _gelu(x):
    return torch.nn.functional.gelu(x, approximate="tanh")
def _silu(x):
    return torch.nn.functional.silu(x)
def _sigmoid(x):
    return torch.sigmoid(x)
def _layernorm(x, axis=-1, eps=1e-5):
    m = x.mean(dim=axis, keepdim=True)
    v = x.var(dim=axis, keepdim=True, unbiased=False)
    return (x - m) / torch.sqrt(v + eps)
def _scatter_add(tgt, idx, src, axis=0):
    return tgt.clone().index_add_(axis, idx, src)
def _segment_sum(src, seg, n):
    out = torch.zeros((n,) + src.shape[1:], dtype=src.dtype)
    return out.index_add_(0, seg, src)
def _pad(x, pw):
    flat = tuple(v for pair in reversed(pw) for v in pair)
    return torch.nn.functional.pad(x, flat)

kernel_name = 'parallel_sum__sliding_block_cached__glu_gated_reglu__decode'

def setup_inputs():

    _w = (lambda a: (lambda t: t.to(torch.bfloat16) if t.is_floating_point() else t)(torch.as_tensor(a)))
    def _A_setup():
        B, Sq, D = 1, 1, 576
        Hq, Hkv, Sk, Dh = 32, 16, 32768, 128
        assert Hq % Hkv == 0, (Hq, Hkv)
        return {
            "x": _w((lambda *s: torch.randn(*s, dtype=torch.bfloat16) * 0.05)(B, Sq, D)),
            "k_cache": _w((lambda *s: torch.randn(*s, dtype=torch.bfloat16) * 1.6)(B, Hkv, Sk, Dh)),
            "v_cache": _w((lambda *s: torch.randn(*s, dtype=torch.bfloat16) * 0.8)(B, Hkv, Sk, Dh)),
            "wq": _w((lambda *s: torch.randn(*s, dtype=torch.bfloat16) * 1.6)(D, Hq * Dh) * (D ** -0.5)),
            "wo": _w((lambda *s: torch.randn(*s, dtype=torch.bfloat16) * 0.8)(Hq * Dh, D) * ((Hq * Dh) ** -0.5)),
        }
    _A_in = _A_setup()

    def _B_setup():
        B, S, D, F = 1, 1, 576, 4608
        return {
            "x": _w((lambda *s: torch.randn(*s, dtype=torch.bfloat16) * 0.05)(B, S, D)),
            "W_gate": _w((lambda *s: torch.randn(*s, dtype=torch.bfloat16) * 0.4)(D, F) * (2.0 / D) ** 0.5),
            "W_up": _w((lambda *s: torch.randn(*s, dtype=torch.bfloat16) * 0.4)(D, F) * (2.0 / D) ** 0.5),
            "W_down": _w((lambda *s: torch.randn(*s, dtype=torch.bfloat16) * 0.4)(F, D) * (1.0 / F) ** 0.5),
        }
    _B_in = _B_setup()

    return {
        "A_x": _A_in["x"],
        "A_k_cache": _A_in["k_cache"],
        "A_v_cache": _A_in["v_cache"],
        "A_wq": _A_in["wq"],
        "A_wo": _A_in["wo"],
        "B_x": _B_in["x"],
        "B_W_gate": _B_in["W_gate"],
        "B_W_up": _B_in["W_up"],
        "B_W_down": _B_in["W_down"],
    }

def reference(A_x, A_k_cache, A_v_cache, A_wq, A_wo, B_x, B_W_gate, B_W_up, B_W_down):
    def _A_ref(x, k_cache, v_cache, wq, wo):
        B, Sq, D = x.shape
        Hq, Dh = 32, 128
        Hkv, Sk = k_cache.shape[1], k_cache.shape[2]
        W = min(4096, max(256, Sk // 4))
        rep = Hq // Hkv
        q = (lambda x, *d: x.permute(*d))((x @ wq).reshape(B, Sq, Hq, Dh), 0, 2, 1, 3)
        k = (lambda x, n, axis: torch.repeat_interleave(x, n, dim=axis))(k_cache[:, :, Sk - W:, :], rep, axis=1)
        v = (lambda x, n, axis: torch.repeat_interleave(x, n, dim=axis))(v_cache[:, :, Sk - W:, :], rep, axis=1)
        scores = torch.einsum("bhqd,bhkd->bhqk", q, k) * (Dh ** -0.5)
        p = _softmax(scores, axis=-1)
        o = torch.einsum("bhqk,bhkd->bhqd", p, v)
        return (lambda x, *d: x.permute(*d))(o, 0, 2, 1, 3).reshape(B, Sq, Hq * Dh) @ wo

    def _B_ref(x, W_gate, W_up, W_down):
        gate = torch.einsum("bsd,df->bsf", x, W_gate)
        up = torch.einsum("bsd,df->bsf", x, W_up)
        gate = gate * (lambda x, dt: x.to(dt))(gate > 0, gate.dtype)
        h = gate * up
        return torch.einsum("bsf,fd->bsd", h, W_down)

    x = A_x
    xn = _layernorm(x, axis=-1)
    return x + _A_ref(xn, A_k_cache, A_v_cache, A_wq, A_wo) + _B_ref(xn, B_W_gate, B_W_up, B_W_down)
```

```asm
; @launch grid=(256,1,1) block=(576,1,1) lds=23552
.amdgcn_target "amdgcn-amd-amdhsa--gfx950"
.text
.globl parallel_sum__sliding_block_cached__glu_gated_reglu__decode_kernel
.p2align 8
.type parallel_sum__sliding_block_cached__glu_gated_reglu__decode_kernel,@function
parallel_sum__sliding_block_cached__glu_gated_reglu__decode_kernel:
    s_cmp_ge_u32 s2, 256
    s_cbranch_scc1 L_end
    s_load_dwordx16 s[4:19], s[0:1], 0
    s_load_dwordx8 s[20:27], s[0:1], 64
    v_lshrrev_b32 v1, 6, v0
    v_and_b32 v2, 63, v0
    v_readfirstlane_b32 s28, v1
    s_lshr_b32 s29, s2, 4
    s_and_b32 s30, s2, 15
    s_waitcnt lgkmcnt(0)
    s_mov_b32 s36, s4
    s_and_b32 s37, s5, 0xffff
    s_movk_i32 s38, 1152
    s_mov_b32 s39, 0x20000
    s_cmp_eq_u32 s28, 8
    s_cbranch_scc1 L_comm
    v_lshlrev_b32 v40, 4, v2
    v_add_u32 v41, 4096, v40
    buffer_load_dwordx4 v[8:11], v40, s[36:39], 0 offen
    buffer_load_dwordx4 v[12:15], v40, s[36:39], 0 offen offset:1024
    s_lshr_b32 s40, s2, 2
    s_and_b32 s41, s2, 3
    s_mul_i32 s42, s41, 144*8192
    s_lshl_b32 s43, s40, 7
    s_add_u32 s42, s42, s43
    s_add_u32 s54, s10, s42
    s_addc_u32 s55, s11, 0
    v_lshrrev_b32 v3, 3, v0
    v_and_b32 v4, 7, v0
    v_lshlrev_b32 v5, 13, v3
    v_lshl_add_u32 v5, v4, 4, v5
    s_mul_i32 s41, s41, 144
    v_add_u32 v42, s41, v3
    v_lshlrev_b32 v42, 2, v42
    s_cmp_ge_u32 s28, 6
    s_cbranch_scc1 L_skipA1
    global_load_dwordx4 v[48:51], v5, s[54:55] nt
    v_add_u32 v5, 393216, v5
    global_load_dwordx4 v[52:55], v5, s[54:55] nt
    v_add_u32 v5, 393216, v5
    global_load_dwordx4 v[56:59], v5, s[54:55] nt
L_skipA1:
    v_mul_u32_u24 v3, 911, v0
    v_lshrrev_b32 v3, 16, v3
    v_mul_u32_u24 v4, 72, v3
    v_sub_u32 v4, v0, v4
    v_lshrrev_b32 v6, 3, v4
    v_and_b32 v7, 7, v4
    s_mul_i32 s40, s29, 9
    v_add_u32 v6, s40, v6
    v_cmp_gt_u32 vcc, 72, v6
    v_subrev_u32 v16, 72, v6
    v_mov_b32 v17, s18
    v_mov_b32 v18, s16
    v_cndmask_b32 v6, v16, v6, vcc
    v_cndmask_b32 v17, v17, v18, vcc
    v_mov_b32 v19, s19
    v_mov_b32 v20, s17
    v_cndmask_b32 v19, v19, v20, vcc
    s_mul_i32 s44, s30, 36
    v_add_u32 v22, s44, v3
    v_mul_u32_u24 v23, 9216, v22
    v_lshl_add_u32 v23, v6, 7, v23
    v_lshl_add_u32 v23, v7, 4, v23
    v_add_co_u32 v16, vcc, v17, v23
    v_addc_co_u32 v17, vcc, 0, v19, vcc
    v_lshlrev_b32 v46, 2, v22
    v_mul_u32_u24 v47, 2304, v3
    v_lshl_add_u32 v47, v4, 5, v47
    v_lshlrev_b32 v1, 2, v3
    s_mov_b32 s48, 55296
    s_cmp_eq_u32 s28, 7
    s_cbranch_scc1 L_skipA
    s_movk_i32 s49, 432
    v_cmp_gt_u32 vcc, s49, v0
    s_and_saveexec_b64 s[46:47], vcc
    global_load_dwordx4 v[60:63], v[16:17], off nt
    v_add_co_u32 v16, vcc, s48, v16
    v_addc_co_u32 v17, vcc, 0, v17, vcc
    global_load_dwordx4 v[64:67], v[16:17], off nt
    v_add_co_u32 v16, vcc, s48, v16
    v_addc_co_u32 v17, vcc, 0, v17, vcc
    global_load_dwordx4 v[68:71], v[16:17], off nt
    v_add_co_u32 v16, vcc, s48, v16
    v_addc_co_u32 v17, vcc, 0, v17, vcc
    global_load_dwordx4 v[72:75], v[16:17], off nt
    v_add_co_u32 v16, vcc, s48, v16
    v_addc_co_u32 v17, vcc, 0, v17, vcc
    global_load_dwordx4 v[76:79], v[16:17], off nt
    v_add_co_u32 v16, vcc, s48, v16
    v_addc_co_u32 v17, vcc, 0, v17, vcc
    global_load_dwordx4 v[80:83], v[16:17], off nt
    s_mov_b64 exec, s[46:47]
L_skipA:
    s_cmp_eq_u32 s28, 7
    s_cbranch_scc1 L_w7x
    s_cmp_eq_u32 s28, 6
    s_cbranch_scc1 L_w6x
    s_waitcnt vmcnt(9)
    s_branch L_xok
L_w6x:
    s_waitcnt vmcnt(6)
    s_branch L_xok
L_w7x:
    s_waitcnt vmcnt(0)
L_xok:
    v_cmp_gt_u32 vcc, 8, v2
    s_nop 1
    v_cndmask_b32 v45, 0, 1.0, vcc
    v_lshlrev_b32 v16, 16, v8
    v_and_b32 v17, 0xffff0000, v8
    v_lshlrev_b32 v18, 16, v9
    v_and_b32 v19, 0xffff0000, v9
    v_lshlrev_b32 v20, 16, v10
    v_and_b32 v21, 0xffff0000, v10
    v_lshlrev_b32 v22, 16, v11
    v_and_b32 v23, 0xffff0000, v11
    v_lshlrev_b32 v24, 16, v12
    v_and_b32 v25, 0xffff0000, v12
    v_lshlrev_b32 v26, 16, v13
    v_and_b32 v27, 0xffff0000, v13
    v_lshlrev_b32 v28, 16, v14
    v_and_b32 v29, 0xffff0000, v14
    v_lshlrev_b32 v30, 16, v15
    v_and_b32 v31, 0xffff0000, v15
    v_add_f32 v32, v16, v17
    v_add_f32 v32, v32, v18
    v_add_f32 v32, v32, v19
    v_add_f32 v32, v32, v20
    v_add_f32 v32, v32, v21
    v_add_f32 v32, v32, v22
    v_add_f32 v32, v32, v23
    v_add_f32 v32, v32, v24
    v_add_f32 v32, v32, v25
    v_add_f32 v32, v32, v26
    v_add_f32 v32, v32, v27
    v_add_f32 v32, v32, v28
    v_add_f32 v32, v32, v29
    v_add_f32 v32, v32, v30
    v_add_f32 v32, v32, v31
    s_nop 1
    v_add_f32_dpp v32, v32, v32 row_ror:8 row_mask:0xf bank_mask:0xf
    s_nop 1
    v_add_f32_dpp v32, v32, v32 row_ror:4 row_mask:0xf bank_mask:0xf
    s_nop 1
    v_add_f32_dpp v32, v32, v32 row_ror:2 row_mask:0xf bank_mask:0xf
    s_nop 1
    v_add_f32_dpp v32, v32, v32 row_ror:1 row_mask:0xf bank_mask:0xf
    s_nop 1
    v_readlane_b32 s64, v32, 0
    v_readlane_b32 s65, v32, 16
    v_readlane_b32 s66, v32, 32
    v_readlane_b32 s67, v32, 48
    s_nop 1
    v_mov_b32 v32, s64
    v_add_f32 v32, s65, v32
    v_add_f32 v32, s66, v32
    v_add_f32 v32, s67, v32
    v_mul_f32 v32, 0x3ae38e39, v32
    v_sub_f32 v34, v16, v32
    v_mul_f32 v33, v34, v34
    v_sub_f32 v34, v17, v32
    v_fmac_f32 v33, v34, v34
    v_sub_f32 v34, v18, v32
    v_fmac_f32 v33, v34, v34
    v_sub_f32 v34, v19, v32
    v_fmac_f32 v33, v34, v34
    v_sub_f32 v34, v20, v32
    v_fmac_f32 v33, v34, v34
    v_sub_f32 v34, v21, v32
    v_fmac_f32 v33, v34, v34
    v_sub_f32 v34, v22, v32
    v_fmac_f32 v33, v34, v34
    v_sub_f32 v34, v23, v32
    v_fmac_f32 v33, v34, v34
    v_sub_f32 v34, v24, v32
    v_mul_f32 v34, v34, v45
    v_fmac_f32 v33, v34, v34
    v_sub_f32 v34, v25, v32
    v_mul_f32 v34, v34, v45
    v_fmac_f32 v33, v34, v34
    v_sub_f32 v34, v26, v32
    v_mul_f32 v34, v34, v45
    v_fmac_f32 v33, v34, v34
    v_sub_f32 v34, v27, v32
    v_mul_f32 v34, v34, v45
    v_fmac_f32 v33, v34, v34
    v_sub_f32 v34, v28, v32
    v_mul_f32 v34, v34, v45
    v_fmac_f32 v33, v34, v34
    v_sub_f32 v34, v29, v32
    v_mul_f32 v34, v34, v45
    v_fmac_f32 v33, v34, v34
    v_sub_f32 v34, v30, v32
    v_mul_f32 v34, v34, v45
    v_fmac_f32 v33, v34, v34
    v_sub_f32 v34, v31, v32
    v_mul_f32 v34, v34, v45
    v_fmac_f32 v33, v34, v34
    s_nop 1
    v_add_f32_dpp v33, v33, v33 row_ror:8 row_mask:0xf bank_mask:0xf
    s_nop 1
    v_add_f32_dpp v33, v33, v33 row_ror:4 row_mask:0xf bank_mask:0xf
    s_nop 1
    v_add_f32_dpp v33, v33, v33 row_ror:2 row_mask:0xf bank_mask:0xf
    s_nop 1
    v_add_f32_dpp v33, v33, v33 row_ror:1 row_mask:0xf bank_mask:0xf
    s_nop 1
    v_readlane_b32 s64, v33, 0
    v_readlane_b32 s65, v33, 16
    v_readlane_b32 s66, v33, 32
    v_readlane_b32 s67, v33, 48
    s_nop 1
    v_mov_b32 v33, s64
    v_add_f32 v33, s65, v33
    v_add_f32 v33, s66, v33
    v_add_f32 v33, s67, v33
    v_mul_f32 v33, 0x3ae38e39, v33
    v_cvt_pk_bf16_f32 v32, v32, v32
    v_lshlrev_b32 v32, 16, v32
    v_cvt_pk_bf16_f32 v33, v33, v33
    v_lshlrev_b32 v33, 16, v33
    v_add_f32 v33, 0x3727c5ac, v33
    v_cvt_pk_bf16_f32 v33, v33, v33
    v_lshlrev_b32 v33, 16, v33
    v_sqrt_f32 v33, v33
    s_nop 0
    v_cvt_pk_bf16_f32 v33, v33, v33
    v_lshlrev_b32 v33, 16, v33
    v_rcp_f32 v33, v33
    s_nop 0
    v_sub_f32 v16, v16, v32
    v_cvt_pk_bf16_f32 v16, v16, v16
    v_lshlrev_b32 v16, 16, v16
    v_mul_f32 v16, v16, v33
    v_cvt_pk_bf16_f32 v16, v16, v16
    v_lshlrev_b32 v16, 16, v16
    v_sub_f32 v17, v17, v32
    v_cvt_pk_bf16_f32 v17, v17, v17
    v_lshlrev_b32 v17, 16, v17
    v_mul_f32 v17, v17, v33
    v_cvt_pk_bf16_f32 v17, v17, v17
    v_lshlrev_b32 v17, 16, v17
    v_sub_f32 v18, v18, v32
    v_cvt_pk_bf16_f32 v18, v18, v18
    v_lshlrev_b32 v18, 16, v18
    v_mul_f32 v18, v18, v33
    v_cvt_pk_bf16_f32 v18, v18, v18
    v_lshlrev_b32 v18, 16, v18
    v_sub_f32 v19, v19, v32
    v_cvt_pk_bf16_f32 v19, v19, v19
    v_lshlrev_b32 v19, 16, v19
    v_mul_f32 v19, v19, v33
    v_cvt_pk_bf16_f32 v19, v19, v19
    v_lshlrev_b32 v19, 16, v19
    v_sub_f32 v20, v20, v32
    v_cvt_pk_bf16_f32 v20, v20, v20
    v_lshlrev_b32 v20, 16, v20
    v_mul_f32 v20, v20, v33
    v_cvt_pk_bf16_f32 v20, v20, v20
    v_lshlrev_b32 v20, 16, v20
    v_sub_f32 v21, v21, v32
    v_cvt_pk_bf16_f32 v21, v21, v21
    v_lshlrev_b32 v21, 16, v21
    v_mul_f32 v21, v21, v33
    v_cvt_pk_bf16_f32 v21, v21, v21
    v_lshlrev_b32 v21, 16, v21
    v_sub_f32 v22, v22, v32
    v_cvt_pk_bf16_f32 v22, v22, v22
    v_lshlrev_b32 v22, 16, v22
    v_mul_f32 v22, v22, v33
    v_cvt_pk_bf16_f32 v22, v22, v22
    v_lshlrev_b32 v22, 16, v22
    v_sub_f32 v23, v23, v32
    v_cvt_pk_bf16_f32 v23, v23, v23
    v_lshlrev_b32 v23, 16, v23
    v_mul_f32 v23, v23, v33
    v_cvt_pk_bf16_f32 v23, v23, v23
    v_lshlrev_b32 v23, 16, v23
    v_sub_f32 v24, v24, v32
    v_cvt_pk_bf16_f32 v24, v24, v24
    v_lshlrev_b32 v24, 16, v24
    v_mul_f32 v24, v24, v33
    v_cvt_pk_bf16_f32 v24, v24, v24
    v_lshlrev_b32 v24, 16, v24
    v_sub_f32 v25, v25, v32
    v_cvt_pk_bf16_f32 v25, v25, v25
    v_lshlrev_b32 v25, 16, v25
    v_mul_f32 v25, v25, v33
    v_cvt_pk_bf16_f32 v25, v25, v25
    v_lshlrev_b32 v25, 16, v25
    v_sub_f32 v26, v26, v32
    v_cvt_pk_bf16_f32 v26, v26, v26
    v_lshlrev_b32 v26, 16, v26
    v_mul_f32 v26, v26, v33
    v_cvt_pk_bf16_f32 v26, v26, v26
    v_lshlrev_b32 v26, 16, v26
    v_sub_f32 v27, v27, v32
    v_cvt_pk_bf16_f32 v27, v27, v27
    v_lshlrev_b32 v27, 16, v27
    v_mul_f32 v27, v27, v33
    v_cvt_pk_bf16_f32 v27, v27, v27
    v_lshlrev_b32 v27, 16, v27
    v_sub_f32 v28, v28, v32
    v_cvt_pk_bf16_f32 v28, v28, v28
    v_lshlrev_b32 v28, 16, v28
    v_mul_f32 v28, v28, v33
    v_cvt_pk_bf16_f32 v28, v28, v28
    v_lshlrev_b32 v28, 16, v28
    v_sub_f32 v29, v29, v32
    v_cvt_pk_bf16_f32 v29, v29, v29
    v_lshlrev_b32 v29, 16, v29
    v_mul_f32 v29, v29, v33
    v_cvt_pk_bf16_f32 v29, v29, v29
    v_lshlrev_b32 v29, 16, v29
    v_sub_f32 v30, v30, v32
    v_cvt_pk_bf16_f32 v30, v30, v30
    v_lshlrev_b32 v30, 16, v30
    v_mul_f32 v30, v30, v33
    v_cvt_pk_bf16_f32 v30, v30, v30
    v_lshlrev_b32 v30, 16, v30
    v_sub_f32 v31, v31, v32
    v_cvt_pk_bf16_f32 v31, v31, v31
    v_lshlrev_b32 v31, 16, v31
    v_mul_f32 v31, v31, v33
    v_cvt_pk_bf16_f32 v31, v31, v31
    v_lshlrev_b32 v31, 16, v31
    v_lshlrev_b32 v4, 5, v2
    ds_write_b128 v4, v[16:19] offset:0
    ds_write_b128 v4, v[20:23] offset:16
    v_cmp_gt_u32 vcc, 8, v2
    s_and_saveexec_b64 s[46:47], vcc
    ds_write_b128 v4, v[24:27] offset:2048
    ds_write_b128 v4, v[28:31] offset:2064
    s_mov_b64 exec, s[46:47]
    s_cmp_ge_u32 s28, 6
    s_cbranch_scc1 L_skipA1c
    s_waitcnt lgkmcnt(0)
    ds_read_b32 v16, v42 offset:0
    ds_read_b32 v17, v42 offset:192
    ds_read_b32 v18, v42 offset:384
    v_mov_b32 v28, 0
    v_mov_b32 v29, 0
    v_mov_b32 v30, 0
    v_mov_b32 v31, 0
    v_mov_b32 v32, 0
    v_mov_b32 v33, 0
    v_mov_b32 v34, 0
    v_mov_b32 v35, 0
    s_waitcnt lgkmcnt(0)
    s_waitcnt vmcnt(8)
    v_lshlrev_b32 v44, 16, v48
    v_and_b32 v45, 0xffff0000, v48
    v_fmac_f32 v28, v44, v16
    v_fmac_f32 v29, v45, v16
    v_lshlrev_b32 v44, 16, v49
    v_and_b32 v45, 0xffff0000, v49
    v_fmac_f32 v30, v44, v16
    v_fmac_f32 v31, v45, v16
    v_lshlrev_b32 v44, 16, v50
    v_and_b32 v45, 0xffff0000, v50
    v_fmac_f32 v32, v44, v16
    v_fmac_f32 v33, v45, v16
    v_lshlrev_b32 v44, 16, v51
    v_and_b32 v45, 0xffff0000, v51
    v_fmac_f32 v34, v44, v16
    v_fmac_f32 v35, v45, v16
    s_waitcnt vmcnt(7)
    v_lshlrev_b32 v44, 16, v52
    v_and_b32 v45, 0xffff0000, v52
    v_fmac_f32 v28, v44, v17
    v_fmac_f32 v29, v45, v17
    v_lshlrev_b32 v44, 16, v53
    v_and_b32 v45, 0xffff0000, v53
    v_fmac_f32 v30, v44, v17
    v_fmac_f32 v31, v45, v17
    v_lshlrev_b32 v44, 16, v54
    v_and_b32 v45, 0xffff0000, v54
    v_fmac_f32 v32, v44, v17
    v_fmac_f32 v33, v45, v17
    v_lshlrev_b32 v44, 16, v55
    v_and_b32 v45, 0xffff0000, v55
    v_fmac_f32 v34, v44, v17
    v_fmac_f32 v35, v45, v17
    s_waitcnt vmcnt(6)
    v_lshlrev_b32 v44, 16, v56
    v_and_b32 v45, 0xffff0000, v56
    v_fmac_f32 v28, v44, v18
    v_fmac_f32 v29, v45, v18
    v_lshlrev_b32 v44, 16, v57
    v_and_b32 v45, 0xffff0000, v57
    v_fmac_f32 v30, v44, v18
    v_fmac_f32 v31, v45, v18
    v_lshlrev_b32 v44, 16, v58
    v_and_b32 v45, 0xffff0000, v58
    v_fmac_f32 v32, v44, v18
    v_fmac_f32 v33, v45, v18
    v_lshlrev_b32 v44, 16, v59
    v_and_b32 v45, 0xffff0000, v59
    v_fmac_f32 v34, v44, v18
    v_fmac_f32 v35, v45, v18
    s_nop 1
    v_add_f32_dpp v28, v28, v28 row_ror:8 row_mask:0xf bank_mask:0xf
    v_add_f32_dpp v29, v29, v29 row_ror:8 row_mask:0xf bank_mask:0xf
    v_add_f32_dpp v30, v30, v30 row_ror:8 row_mask:0xf bank_mask:0xf
    v_add_f32_dpp v31, v31, v31 row_ror:8 row_mask:0xf bank_mask:0xf
    v_add_f32_dpp v32, v32, v32 row_ror:8 row_mask:0xf bank_mask:0xf
    v_add_f32_dpp v33, v33, v33 row_ror:8 row_mask:0xf bank_mask:0xf
    v_add_f32_dpp v34, v34, v34 row_ror:8 row_mask:0xf bank_mask:0xf
    v_add_f32_dpp v35, v35, v35 row_ror:8 row_mask:0xf bank_mask:0xf
    s_nop 1
    v_permlane32_swap_b32 v28, v32
    v_permlane32_swap_b32 v29, v33
    v_permlane32_swap_b32 v30, v34
    v_permlane32_swap_b32 v31, v35
    v_add_f32 v28, v28, v32
    v_add_f32 v29, v29, v33
    v_add_f32 v30, v30, v34
    v_add_f32 v31, v31, v35
    s_nop 1
    v_permlane16_swap_b32 v28, v30
    v_permlane16_swap_b32 v29, v31
    v_add_f32 v28, v28, v30
    v_add_f32 v29, v29, v31
    v_and_b32 v3, 7, v2
    v_lshlrev_b32 v3, 5, v3
    v_bfe_u32 v4, v2, 4, 1
    v_lshl_add_u32 v3, v4, 3, v3
    v_lshrrev_b32 v4, 5, v2
    v_lshl_add_u32 v3, v4, 4, v3
    s_lshl_b32 s48, s28, 8
    v_add_u32 v3, s48, v3
    ds_write_b64 v3, v[28:29] offset:5888
L_skipA1c:
    s_waitcnt lgkmcnt(0)
    s_barrier
    s_cmp_lg_u32 s28, 0
    s_cbranch_scc1 L_skipP1
    v_mov_b32 v17, 0
    ds_read_b32 v11, v17 offset:3256
    v_cmp_gt_u32 vcc, 22, v0
    s_and_saveexec_b64 s[46:47], vcc
    v_mul_u32_u24 v6, 12, v0
    ds_read_b32 v16, v6 offset:5888
    ds_read_b32 v17, v6 offset:5892
    ds_read_b32 v18, v6 offset:5896
    ds_read_b32 v20, v6 offset:6144
    ds_read_b32 v21, v6 offset:6148
    ds_read_b32 v22, v6 offset:6152
    ds_read_b32 v24, v6 offset:6400
    ds_read_b32 v25, v6 offset:6404
    ds_read_b32 v26, v6 offset:6408
    ds_read_b32 v28, v6 offset:6656
    ds_read_b32 v29, v6 offset:6660
    ds_read_b32 v30, v6 offset:6664
    ds_read_b32 v32, v6 offset:6912
    ds_read_b32 v33, v6 offset:6916
    ds_read_b32 v34, v6 offset:6920
    ds_read_b32 v36, v6 offset:7168
    ds_read_b32 v37, v6 offset:7172
    ds_read_b32 v38, v6 offset:7176
    s_mul_i32 s48, s2, 352
    s_add_u32 s50, s26, s48
    s_addc_u32 s51, s27, 0
    v_lshlrev_b32 v4, 4, v0
    s_waitcnt lgkmcnt(0)
    v_add_f32 v8, v16, v20
    v_add_f32 v8, v8, v24
    v_add_f32 v8, v8, v28
    v_add_f32 v8, v8, v32
    v_add_f32 v8, v8, v36
    v_add_f32 v9, v17, v21
    v_add_f32 v9, v9, v25
    v_add_f32 v9, v9, v29
    v_add_f32 v9, v9, v33
    v_add_f32 v9, v9, v37
    v_add_f32 v10, v18, v22
    v_add_f32 v10, v10, v26
    v_add_f32 v10, v10, v30
    v_add_f32 v10, v10, v34
    v_add_f32 v10, v10, v38
    global_store_dwordx4 v4, v[8:11], s[50:51] sc0 sc1
    s_mov_b64 exec, s[46:47]
L_skipP1:
    s_lshl_b32 s45, s29, 23
    s_lshl_b32 s48, s30, 16
    s_add_u32 s45, s45, s48
    s_lshl_b32 s48, s28, 13
    s_add_u32 s45, s45, s48
    s_add_u32 s45, s45, 7340032
    s_add_u32 s32, s6, s45
    s_addc_u32 s33, s7, 0
    s_add_u32 s34, s8, s45
    s_addc_u32 s35, s9, 0
    global_load_dwordx4 v[84:87], v40, s[32:33] offset:0 nt
    global_load_dwordx4 v[88:91], v40, s[32:33] offset:1024 nt
    global_load_dwordx4 v[92:95], v40, s[32:33] offset:2048 nt
    global_load_dwordx4 v[96:99], v40, s[32:33] offset:3072 nt
    global_load_dwordx4 v[100:103], v41, s[32:33] offset:0 nt
    global_load_dwordx4 v[104:107], v41, s[32:33] offset:1024 nt
    global_load_dwordx4 v[108:111], v41, s[32:33] offset:2048 nt
    global_load_dwordx4 v[112:115], v41, s[32:33] offset:3072 nt
    global_load_dwordx4 v[116:119], v40, s[34:35] offset:0 nt
    global_load_dwordx4 v[120:123], v40, s[34:35] offset:1024 nt
    global_load_dwordx4 v[124:127], v40, s[34:35] offset:2048 nt
    global_load_dwordx4 v[128:131], v40, s[34:35] offset:3072 nt
    global_load_dwordx4 v[132:135], v41, s[34:35] offset:0 nt
    global_load_dwordx4 v[136:139], v41, s[34:35] offset:1024 nt
    global_load_dwordx4 v[140:143], v41, s[34:35] offset:2048 nt
    global_load_dwordx4 v[144:147], v41, s[34:35] offset:3072 nt
    s_cmp_eq_u32 s28, 7
    s_cbranch_scc1 L_skipA2
    s_movk_i32 s49, 432
    v_cmp_gt_u32 vcc, s49, v0
    s_and_saveexec_b64 s[46:47], vcc
    ds_read_b32 v16, v46 offset:0
    ds_read_b32 v17, v46 offset:24
    ds_read_b32 v18, v46 offset:48
    ds_read_b32 v19, v46 offset:72
    ds_read_b32 v20, v46 offset:96
    ds_read_b32 v21, v46 offset:120
    v_mov_b32 v28, 0
    v_mov_b32 v29, 0
    v_mov_b32 v30, 0
    v_mov_b32 v31, 0
    v_mov_b32 v32, 0
    v_mov_b32 v33, 0
    v_mov_b32 v34, 0
    v_mov_b32 v35, 0
    s_waitcnt lgkmcnt(0)
    s_waitcnt vmcnt(21)
    v_lshlrev_b32 v44, 16, v60
    v_and_b32 v45, 0xffff0000, v60
    v_fmac_f32 v28, v44, v16
    v_fmac_f32 v29, v45, v16
    v_lshlrev_b32 v44, 16, v61
    v_and_b32 v45, 0xffff0000, v61
    v_fmac_f32 v30, v44, v16
    v_fmac_f32 v31, v45, v16
    v_lshlrev_b32 v44, 16, v62
    v_and_b32 v45, 0xffff0000, v62
    v_fmac_f32 v32, v44, v16
    v_fmac_f32 v33, v45, v16
    v_lshlrev_b32 v44, 16, v63
    v_and_b32 v45, 0xffff0000, v63
    v_fmac_f32 v34, v44, v16
    v_fmac_f32 v35, v45, v16
    s_waitcnt vmcnt(20)
    v_lshlrev_b32 v44, 16, v64
    v_and_b32 v45, 0xffff0000, v64
    v_fmac_f32 v28, v44, v17
    v_fmac_f32 v29, v45, v17
    v_lshlrev_b32 v44, 16, v65
    v_and_b32 v45, 0xffff0000, v65
    v_fmac_f32 v30, v44, v17
    v_fmac_f32 v31, v45, v17
    v_lshlrev_b32 v44, 16, v66
    v_and_b32 v45, 0xffff0000, v66
    v_fmac_f32 v32, v44, v17
    v_fmac_f32 v33, v45, v17
    v_lshlrev_b32 v44, 16, v67
    v_and_b32 v45, 0xffff0000, v67
    v_fmac_f32 v34, v44, v17
    v_fmac_f32 v35, v45, v17
    s_waitcnt vmcnt(19)
    v_lshlrev_b32 v44, 16, v68
    v_and_b32 v45, 0xffff0000, v68
    v_fmac_f32 v28, v44, v18
    v_fmac_f32 v29, v45, v18
    v_lshlrev_b32 v44, 16, v69
    v_and_b32 v45, 0xffff0000, v69
    v_fmac_f32 v30, v44, v18
    v_fmac_f32 v31, v45, v18
    v_lshlrev_b32 v44, 16, v70
    v_and_b32 v45, 0xffff0000, v70
    v_fmac_f32 v32, v44, v18
    v_fmac_f32 v33, v45, v18
    v_lshlrev_b32 v44, 16, v71
    v_and_b32 v45, 0xffff0000, v71
    v_fmac_f32 v34, v44, v18
    v_fmac_f32 v35, v45, v18
    s_waitcnt vmcnt(18)
    v_lshlrev_b32 v44, 16, v72
    v_and_b32 v45, 0xffff0000, v72
    v_fmac_f32 v28, v44, v19
    v_fmac_f32 v29, v45, v19
    v_lshlrev_b32 v44, 16, v73
    v_and_b32 v45, 0xffff0000, v73
    v_fmac_f32 v30, v44, v19
    v_fmac_f32 v31, v45, v19
    v_lshlrev_b32 v44, 16, v74
    v_and_b32 v45, 0xffff0000, v74
    v_fmac_f32 v32, v44, v19
    v_fmac_f32 v33, v45, v19
    v_lshlrev_b32 v44, 16, v75
    v_and_b32 v45, 0xffff0000, v75
    v_fmac_f32 v34, v44, v19
    v_fmac_f32 v35, v45, v19
    s_waitcnt vmcnt(17)
    v_lshlrev_b32 v44, 16, v76
    v_and_b32 v45, 0xffff0000, v76
    v_fmac_f32 v28, v44, v20
    v_fmac_f32 v29, v45, v20
    v_lshlrev_b32 v44, 16, v77
    v_and_b32 v45, 0xffff0000, v77
    v_fmac_f32 v30, v44, v20
    v_fmac_f32 v31, v45, v20
    v_lshlrev_b32 v44, 16, v78
    v_and_b32 v45, 0xffff0000, v78
    v_fmac_f32 v32, v44, v20
    v_fmac_f32 v33, v45, v20
    v_lshlrev_b32 v44, 16, v79
    v_and_b32 v45, 0xffff0000, v79
    v_fmac_f32 v34, v44, v20
    v_fmac_f32 v35, v45, v20
    s_waitcnt vmcnt(16)
    v_lshlrev_b32 v44, 16, v80
    v_and_b32 v45, 0xffff0000, v80
    v_fmac_f32 v28, v44, v21
    v_fmac_f32 v29, v45, v21
    v_lshlrev_b32 v44, 16, v81
    v_and_b32 v45, 0xffff0000, v81
    v_fmac_f32 v30, v44, v21
    v_fmac_f32 v31, v45, v21
    v_lshlrev_b32 v44, 16, v82
    v_and_b32 v45, 0xffff0000, v82
    v_fmac_f32 v32, v44, v21
    v_fmac_f32 v33, v45, v21
    v_lshlrev_b32 v44, 16, v83
    v_and_b32 v45, 0xffff0000, v83
    v_fmac_f32 v34, v44, v21
    v_fmac_f32 v35, v45, v21
    ds_write_b128 v47, v[28:31] offset:7424
    ds_write_b128 v47, v[32:35] offset:7440
    s_mov_b64 exec, s[46:47]
    s_waitcnt lgkmcnt(0)
    v_mov_b32 v17, 0
    v_mov_b32 v16, 1
    s_mov_b64 exec, 1
    ds_add_u32 v17, v16 offset:3252
    s_mov_b64 exec, -1
L_skipA2:
    s_cmp_ge_u32 s28, 4
    s_cbranch_scc1 L_skipPA0
    v_mov_b32 v17, 0
L_spin:
    ds_read_b32 v16, v17 offset:3252
    s_waitcnt lgkmcnt(0)
    v_readfirstlane_b32 s48, v16
    s_cmp_lt_u32 s48, 7
    s_cbranch_scc1 L_spin
    ds_read_b32 v11, v17 offset:3256
    s_movk_i32 s48, 198
    v_cmp_gt_u32 vcc, s48, v0
    s_and_saveexec_b64 s[46:47], vcc
    v_mul_u32_u24 v5, 745, v0
    v_lshrrev_b32 v5, 14, v5
    v_mul_u32_u24 v6, 22, v5
    v_sub_u32 v6, v0, v6
    v_mul_u32_u24 v6, 12, v6
    v_lshl_add_u32 v6, v5, 8, v6
    ds_read_b32 v16, v6 offset:7424
    ds_read_b32 v17, v6 offset:7428
    ds_read_b32 v18, v6 offset:7432
    ds_read_b32 v20, v6 offset:9728
    ds_read_b32 v21, v6 offset:9732
    ds_read_b32 v22, v6 offset:9736
    ds_read_b32 v24, v6 offset:12032
    ds_read_b32 v25, v6 offset:12036
    ds_read_b32 v26, v6 offset:12040
    ds_read_b32 v28, v6 offset:14336
    ds_read_b32 v29, v6 offset:14340
    ds_read_b32 v30, v6 offset:14344
    ds_read_b32 v32, v6 offset:16640
    ds_read_b32 v33, v6 offset:16644
    ds_read_b32 v34, v6 offset:16648
    ds_read_b32 v36, v6 offset:18944
    ds_read_b32 v37, v6 offset:18948
    ds_read_b32 v38, v6 offset:18952
    s_mul_i32 s48, s2, 3168
    s_add_u32 s48, s48, 98304
    s_add_u32 s50, s26, s48
    s_addc_u32 s51, s27, 0
    v_lshlrev_b32 v4, 4, v0
    s_waitcnt lgkmcnt(0)
    v_add_f32 v8, v16, v20
    v_add_f32 v8, v8, v24
    v_add_f32 v8, v8, v28
    v_add_f32 v8, v8, v32
    v_add_f32 v8, v8, v36
    v_add_f32 v9, v17, v21
    v_add_f32 v9, v9, v25
    v_add_f32 v9, v9, v29
    v_add_f32 v9, v9, v33
    v_add_f32 v9, v9, v37
    v_add_f32 v10, v18, v22
    v_add_f32 v10, v10, v26
    v_add_f32 v10, v10, v30
    v_add_f32 v10, v10, v34
    v_add_f32 v10, v10, v38
    global_store_dwordx4 v4, v[8:11], s[50:51] sc0 sc1
    s_mov_b64 exec, s[46:47]
L_skipPA0:
    s_barrier
    v_mul_u32_u24 v3, 911, v0
    v_lshrrev_b32 v3, 16, v3
    v_mul_u32_u24 v4, 72, v3
    v_sub_u32 v4, v0, v4
    s_mul_i32 s48, s2, 16*1152
    s_add_u32 s50, s12, s48
    s_addc_u32 s51, s13, 0
    s_mul_i32 s48, s2, 18*1152
    s_add_u32 s52, s20, s48
    s_addc_u32 s53, s21, 0
    s_sub_u32 s52, s52, 16*1152
    s_subb_u32 s53, s53, 0
    v_mov_b32 v24, s50
    v_mov_b32 v25, s51
    v_mov_b32 v26, s52
    v_mov_b32 v27, s53
    v_add_u32 v5, 0, v3
    v_min_u32 v5, 33, v5
    v_cmp_gt_u32 vcc, 16, v5
    v_mul_u32_u24 v6, 1152, v5
    v_lshl_add_u32 v6, v4, 4, v6
    v_cndmask_b32 v28, v26, v24, vcc
    v_cndmask_b32 v29, v27, v25, vcc
    v_add_co_u32 v16, vcc, v28, v6
    v_addc_co_u32 v17, vcc, 0, v29, vcc
    global_load_dwordx4 v[148:151], v[16:17], off nt
    v_add_u32 v5, 7, v3
    v_min_u32 v5, 33, v5
    v_cmp_gt_u32 vcc, 16, v5
    v_mul_u32_u24 v6, 1152, v5
    v_lshl_add_u32 v6, v4, 4, v6
    v_cndmask_b32 v28, v26, v24, vcc
    v_cndmask_b32 v29, v27, v25, vcc
    v_add_co_u32 v16, vcc, v28, v6
    v_addc_co_u32 v17, vcc, 0, v29, vcc
    global_load_dwordx4 v[152:155], v[16:17], off nt
    v_add_u32 v5, 14, v3
    v_min_u32 v5, 33, v5
    v_cmp_gt_u32 vcc, 16, v5
    v_mul_u32_u24 v6, 1152, v5
    v_lshl_add_u32 v6, v4, 4, v6
    v_cndmask_b32 v28, v26, v24, vcc
    v_cndmask_b32 v29, v27, v25, vcc
    v_add_co_u32 v16, vcc, v28, v6
    v_addc_co_u32 v17, vcc, 0, v29, vcc
    global_load_dwordx4 v[156:159], v[16:17], off nt
    v_add_u32 v5, 21, v3
    v_min_u32 v5, 33, v5
    v_cmp_gt_u32 vcc, 16, v5
    v_mul_u32_u24 v6, 1152, v5
    v_lshl_add_u32 v6, v4, 4, v6
    v_cndmask_b32 v28, v26, v24, vcc
    v_cndmask_b32 v29, v27, v25, vcc
    v_add_co_u32 v16, vcc, v28, v6
    v_addc_co_u32 v17, vcc, 0, v29, vcc
    global_load_dwordx4 v[160:163], v[16:17], off nt
    v_add_u32 v5, 28, v3
    v_min_u32 v5, 33, v5
    v_cmp_gt_u32 vcc, 16, v5
    v_mul_u32_u24 v6, 1152, v5
    v_lshl_add_u32 v6, v4, 4, v6
    v_cndmask_b32 v28, v26, v24, vcc
    v_cndmask_b32 v29, v27, v25, vcc
    v_add_co_u32 v16, vcc, v28, v6
    v_addc_co_u32 v17, vcc, 0, v29, vcc
    global_load_dwordx4 v[164:167], v[16:17], off nt
    v_and_b32 v3, 15, v2
    v_lshlrev_b32 v3, 4, v3
    ds_read_b128 v[8:11], v3 offset:2304
    ds_read_b128 v[12:15], v3 offset:2560
    s_waitcnt lgkmcnt(0)
    s_waitcnt vmcnt(13)
    v_dot2_f32_bf16 v48, v84, v8, 0
    v_dot2_f32_bf16 v49, v84, v12, 0
    v_dot2_f32_bf16 v48, v85, v9, v48
    v_dot2_f32_bf16 v49, v85, v13, v49
    v_dot2_f32_bf16 v48, v86, v10, v48
    v_dot2_f32_bf16 v49, v86, v14, v49
    v_dot2_f32_bf16 v48, v87, v11, v48
    v_dot2_f32_bf16 v49, v87, v15, v49
    v_dot2_f32_bf16 v50, v88, v8, 0
    v_dot2_f32_bf16 v51, v88, v12, 0
    v_dot2_f32_bf16 v50, v89, v9, v50
    v_dot2_f32_bf16 v51, v89, v13, v51
    v_dot2_f32_bf16 v50, v90, v10, v50
    v_dot2_f32_bf16 v51, v90, v14, v51
    v_dot2_f32_bf16 v50, v91, v11, v50
    v_dot2_f32_bf16 v51, v91, v15, v51
    v_dot2_f32_bf16 v52, v92, v8, 0
    v_dot2_f32_bf16 v53, v92, v12, 0
    v_dot2_f32_bf16 v52, v93, v9, v52
    v_dot2_f32_bf16 v53, v93, v13, v53
    v_dot2_f32_bf16 v52, v94, v10, v52
    v_dot2_f32_bf16 v53, v94, v14, v53
    v_dot2_f32_bf16 v52, v95, v11, v52
    v_dot2_f32_bf16 v53, v95, v15, v53
    v_dot2_f32_bf16 v54, v96, v8, 0
    v_dot2_f32_bf16 v55, v96, v12, 0
    v_dot2_f32_bf16 v54, v97, v9, v54
    v_dot2_f32_bf16 v55, v97, v13, v55
    v_dot2_f32_bf16 v54, v98, v10, v54
    v_dot2_f32_bf16 v55, v98, v14, v55
    v_dot2_f32_bf16 v54, v99, v11, v54
    v_dot2_f32_bf16 v55, v99, v15, v55
    v_dot2_f32_bf16 v56, v100, v8, 0
    v_dot2_f32_bf16 v57, v100, v12, 0
    v_dot2_f32_bf16 v56, v101, v9, v56
    v_dot2_f32_bf16 v57, v101, v13, v57
    v_dot2_f32_bf16 v56, v102, v10, v56
    v_dot2_f32_bf16 v57, v102, v14, v57
    v_dot2_f32_bf16 v56, v103, v11, v56
    v_dot2_f32_bf16 v57, v103, v15, v57
    v_dot2_f32_bf16 v58, v104, v8, 0
    v_dot2_f32_bf16 v59, v104, v12, 0
    v_dot2_f32_bf16 v58, v105, v9, v58
    v_dot2_f32_bf16 v59, v105, v13, v59
    v_dot2_f32_bf16 v58, v106, v10, v58
    v_dot2_f32_bf16 v59, v106, v14, v59
    v_dot2_f32_bf16 v58, v107, v11, v58
    v_dot2_f32_bf16 v59, v107, v15, v59
    v_dot2_f32_bf16 v60, v108, v8, 0
    v_dot2_f32_bf16 v61, v108, v12, 0
    v_dot2_f32_bf16 v60, v109, v9, v60
    v_dot2_f32_bf16 v61, v109, v13, v61
    v_dot2_f32_bf16 v60, v110, v10, v60
    v_dot2_f32_bf16 v61, v110, v14, v61
    v_dot2_f32_bf16 v60, v111, v11, v60
    v_dot2_f32_bf16 v61, v111, v15, v61
    v_dot2_f32_bf16 v62, v112, v8, 0
    v_dot2_f32_bf16 v63, v112, v12, 0
    v_dot2_f32_bf16 v62, v113, v9, v62
    v_dot2_f32_bf16 v63, v113, v13, v63
    v_dot2_f32_bf16 v62, v114, v10, v62
    v_dot2_f32_bf16 v63, v114, v14, v63
    v_dot2_f32_bf16 v62, v115, v11, v62
    v_dot2_f32_bf16 v63, v115, v15, v63
    v_add_f32_dpp v48, v48, v48 row_ror:8 row_mask:0xf bank_mask:0xf
    v_add_f32_dpp v49, v49, v49 row_ror:8 row_mask:0xf bank_mask:0xf
    v_add_f32_dpp v50, v50, v50 row_ror:8 row_mask:0xf bank_mask:0xf
    v_add_f32_dpp v51, v51, v51 row_ror:8 row_mask:0xf bank_mask:0xf
    v_add_f32_dpp v52, v52, v52 row_ror:8 row_mask:0xf bank_mask:0xf
    v_add_f32_dpp v53, v53, v53 row_ror:8 row_mask:0xf bank_mask:0xf
    v_add_f32_dpp v54, v54, v54 row_ror:8 row_mask:0xf bank_mask:0xf
    v_add_f32_dpp v55, v55, v55 row_ror:8 row_mask:0xf bank_mask:0xf
    v_add_f32_dpp v56, v56, v56 row_ror:8 row_mask:0xf bank_mask:0xf
    v_add_f32_dpp v57, v57, v57 row_ror:8 row_mask:0xf bank_mask:0xf
    v_add_f32_dpp v58, v58, v58 row_ror:8 row_mask:0xf bank_mask:0xf
    v_add_f32_dpp v59, v59, v59 row_ror:8 row_mask:0xf bank_mask:0xf
    v_add_f32_dpp v60, v60, v60 row_ror:8 row_mask:0xf bank_mask:0xf
    v_add_f32_dpp v61, v61, v61 row_ror:8 row_mask:0xf bank_mask:0xf
    v_add_f32_dpp v62, v62, v62 row_ror:8 row_mask:0xf bank_mask:0xf
    v_add_f32_dpp v63, v63, v63 row_ror:8 row_mask:0xf bank_mask:0xf
    v_add_f32_dpp v48, v48, v48 row_ror:4 row_mask:0xf bank_mask:0xf
    v_add_f32_dpp v49, v49, v49 row_ror:4 row_mask:0xf bank_mask:0xf
    v_add_f32_dpp v50, v50, v50 row_ror:4 row_mask:0xf bank_mask:0xf
    v_add_f32_dpp v51, v51, v51 row_ror:4 row_mask:0xf bank_mask:0xf
    v_add_f32_dpp v52, v52, v52 row_ror:4 row_mask:0xf bank_mask:0xf
    v_add_f32_dpp v53, v53, v53 row_ror:4 row_mask:0xf bank_mask:0xf
    v_add_f32_dpp v54, v54, v54 row_ror:4 row_mask:0xf bank_mask:0xf
    v_add_f32_dpp v55, v55, v55 row_ror:4 row_mask:0xf bank_mask:0xf
    v_add_f32_dpp v56, v56, v56 row_ror:4 row_mask:0xf bank_mask:0xf
    v_add_f32_dpp v57, v57, v57 row_ror:4 row_mask:0xf bank_mask:0xf
    v_add_f32_dpp v58, v58, v58 row_ror:4 row_mask:0xf bank_mask:0xf
    v_add_f32_dpp v59, v59, v59 row_ror:4 row_mask:0xf bank_mask:0xf
    v_add_f32_dpp v60, v60, v60 row_ror:4 row_mask:0xf bank_mask:0xf
    v_add_f32_dpp v61, v61, v61 row_ror:4 row_mask:0xf bank_mask:0xf
    v_add_f32_dpp v62, v62, v62 row_ror:4 row_mask:0xf bank_mask:0xf
    v_add_f32_dpp v63, v63, v63 row_ror:4 row_mask:0xf bank_mask:0xf
    v_add_f32_dpp v48, v48, v48 row_ror:2 row_mask:0xf bank_mask:0xf
    v_add_f32_dpp v49, v49, v49 row_ror:2 row_mask:0xf bank_mask:0xf
    v_add_f32_dpp v50, v50, v50 row_ror:2 row_mask:0xf bank_mask:0xf
    v_add_f32_dpp v51, v51, v51 row_ror:2 row_mask:0xf bank_mask:0xf
    v_add_f32_dpp v52, v52, v52 row_ror:2 row_mask:0xf bank_mask:0xf
    v_add_f32_dpp v53, v53, v53 row_ror:2 row_mask:0xf bank_mask:0xf
    v_add_f32_dpp v54, v54, v54 row_ror:2 row_mask:0xf bank_mask:0xf
    v_add_f32_dpp v55, v55, v55 row_ror:2 row_mask:0xf bank_mask:0xf
    v_add_f32_dpp v56, v56, v56 row_ror:2 row_mask:0xf bank_mask:0xf
    v_add_f32_dpp v57, v57, v57 row_ror:2 row_mask:0xf bank_mask:0xf
    v_add_f32_dpp v58, v58, v58 row_ror:2 row_mask:0xf bank_mask:0xf
    v_add_f32_dpp v59, v59, v59 row_ror:2 row_mask:0xf bank_mask:0xf
    v_add_f32_dpp v60, v60, v60 row_ror:2 row_mask:0xf bank_mask:0xf
    v_add_f32_dpp v61, v61, v61 row_ror:2 row_mask:0xf bank_mask:0xf
    v_add_f32_dpp v62, v62, v62 row_ror:2 row_mask:0xf bank_mask:0xf
    v_add_f32_dpp v63, v63, v63 row_ror:2 row_mask:0xf bank_mask:0xf
    v_add_f32_dpp v48, v48, v48 row_ror:1 row_mask:0xf bank_mask:0xf
    v_add_f32_dpp v49, v49, v49 row_ror:1 row_mask:0xf bank_mask:0xf
    v_add_f32_dpp v50, v50, v50 row_ror:1 row_mask:0xf bank_mask:0xf
    v_add_f32_dpp v51, v51, v51 row_ror:1 row_mask:0xf bank_mask:0xf
    v_add_f32_dpp v52, v52, v52 row_ror:1 row_mask:0xf bank_mask:0xf
    v_add_f32_dpp v53, v53, v53 row_ror:1 row_mask:0xf bank_mask:0xf
    v_add_f32_dpp v54, v54, v54 row_ror:1 row_mask:0xf bank_mask:0xf
    v_add_f32_dpp v55, v55, v55 row_ror:1 row_mask:0xf bank_mask:0xf
    v_add_f32_dpp v56, v56, v56 row_ror:1 row_mask:0xf bank_mask:0xf
    v_add_f32_dpp v57, v57, v57 row_ror:1 row_mask:0xf bank_mask:0xf
    v_add_f32_dpp v58, v58, v58 row_ror:1 row_mask:0xf bank_mask:0xf
    v_add_f32_dpp v59, v59, v59 row_ror:1 row_mask:0xf bank_mask:0xf
    v_add_f32_dpp v60, v60, v60 row_ror:1 row_mask:0xf bank_mask:0xf
    v_add_f32_dpp v61, v61, v61 row_ror:1 row_mask:0xf bank_mask:0xf
    v_add_f32_dpp v62, v62, v62 row_ror:1 row_mask:0xf bank_mask:0xf
    v_add_f32_dpp v63, v63, v63 row_ror:1 row_mask:0xf bank_mask:0xf
    v_mov_b32 v16, 0x3db504f3
    v_mov_b32 v17, 0x3fb8aa3b
    v_cvt_pk_bf16_f32 v64, v48, v49
    v_lshlrev_b32 v48, 16, v64
    v_and_b32 v49, 0xffff0000, v64
    v_pk_mul_f32 v[48:49], v[48:49], v[16:17] op_sel_hi:[1,0]
    v_cvt_pk_bf16_f32 v64, v48, v49
    v_lshlrev_b32 v48, 16, v64
    v_and_b32 v49, 0xffff0000, v64
    v_pk_mul_f32 v[48:49], v[48:49], v[16:17] op_sel:[0,1] op_sel_hi:[1,1]
    v_cvt_pk_bf16_f32 v64, v50, v51
    v_lshlrev_b32 v50, 16, v64
    v_and_b32 v51, 0xffff0000, v64
    v_pk_mul_f32 v[50:51], v[50:51], v[16:17] op_sel_hi:[1,0]
    v_cvt_pk_bf16_f32 v64, v50, v51
    v_lshlrev_b32 v50, 16, v64
    v_and_b32 v51, 0xffff0000, v64
    v_pk_mul_f32 v[50:51], v[50:51], v[16:17] op_sel:[0,1] op_sel_hi:[1,1]
    v_cvt_pk_bf16_f32 v64, v52, v53
    v_lshlrev_b32 v52, 16, v64
    v_and_b32 v53, 0xffff0000, v64
    v_pk_mul_f32 v[52:53], v[52:53], v[16:17] op_sel_hi:[1,0]
    v_cvt_pk_bf16_f32 v64, v52, v53
    v_lshlrev_b32 v52, 16, v64
    v_and_b32 v53, 0xffff0000, v64
    v_pk_mul_f32 v[52:53], v[52:53], v[16:17] op_sel:[0,1] op_sel_hi:[1,1]
    v_cvt_pk_bf16_f32 v64, v54, v55
    v_lshlrev_b32 v54, 16, v64
    v_and_b32 v55, 0xffff0000, v64
    v_pk_mul_f32 v[54:55], v[54:55], v[16:17] op_sel_hi:[1,0]
    v_cvt_pk_bf16_f32 v64, v54, v55
    v_lshlrev_b32 v54, 16, v64
    v_and_b32 v55, 0xffff0000, v64
    v_pk_mul_f32 v[54:55], v[54:55], v[16:17] op_sel:[0,1] op_sel_hi:[1,1]
    v_cvt_pk_bf16_f32 v64, v56, v57
    v_lshlrev_b32 v56, 16, v64
    v_and_b32 v57, 0xffff0000, v64
    v_pk_mul_f32 v[56:57], v[56:57], v[16:17] op_sel_hi:[1,0]
    v_cvt_pk_bf16_f32 v64, v56, v57
    v_lshlrev_b32 v56, 16, v64
    v_and_b32 v57, 0xffff0000, v64
    v_pk_mul_f32 v[56:57], v[56:57], v[16:17] op_sel:[0,1] op_sel_hi:[1,1]
    v_cvt_pk_bf16_f32 v64, v58, v59
    v_lshlrev_b32 v58, 16, v64
    v_and_b32 v59, 0xffff0000, v64
    v_pk_mul_f32 v[58:59], v[58:59], v[16:17] op_sel_hi:[1,0]
    v_cvt_pk_bf16_f32 v64, v58, v59
    v_lshlrev_b32 v58, 16, v64
    v_and_b32 v59, 0xffff0000, v64
    v_pk_mul_f32 v[58:59], v[58:59], v[16:17] op_sel:[0,1] op_sel_hi:[1,1]
    v_cvt_pk_bf16_f32 v64, v60, v61
    v_lshlrev_b32 v60, 16, v64
    v_and_b32 v61, 0xffff0000, v64
    v_pk_mul_f32 v[60:61], v[60:61], v[16:17] op_sel_hi:[1,0]
    v_cvt_pk_bf16_f32 v64, v60, v61
    v_lshlrev_b32 v60, 16, v64
    v_and_b32 v61, 0xffff0000, v64
    v_pk_mul_f32 v[60:61], v[60:61], v[16:17] op_sel:[0,1] op_sel_hi:[1,1]
    v_cvt_pk_bf16_f32 v64, v62, v63
    v_lshlrev_b32 v62, 16, v64
    v_and_b32 v63, 0xffff0000, v64
    v_pk_mul_f32 v[62:63], v[62:63], v[16:17] op_sel_hi:[1,0]
    v_cvt_pk_bf16_f32 v64, v62, v63
    v_lshlrev_b32 v62, 16, v64
    v_and_b32 v63, 0xffff0000, v64
    v_pk_mul_f32 v[62:63], v[62:63], v[16:17] op_sel:[0,1] op_sel_hi:[1,1]
    v_max3_f32 v64, v48, v50, v52
    v_max3_f32 v66, v54, v56, v58
    v_max3_f32 v64, v64, v60, v62
    v_max_f32 v64, v64, v66
    v_max3_f32 v65, v49, v51, v53
    v_max3_f32 v67, v55, v57, v59
    v_max3_f32 v65, v65, v61, v63
    v_max_f32 v65, v65, v67
    s_nop 1
    v_permlane32_swap_b32 v64, v65
    v_max_f32 v64, v64, v65
    v_mov_b32 v65, v64
    s_nop 1
    v_permlane16_swap_b32 v64, v65
    v_max_f32 v64, v64, v65
    s_lshl_b32 s48, s28, 3
    v_lshrrev_b32 v17, 5, v2
    v_lshl_add_u32 v17, v17, 2, s48
    s_mov_b64 s[46:47], exec
    s_mov_b32 exec_lo, 1
    s_mov_b32 exec_hi, 1
    ds_write_b32 v17, v64 offset:2816
    s_waitcnt lgkmcnt(0)
    s_mov_b32 exec_hi, 0
    v_mov_b32 v17, 0
    v_mov_b32 v16, 1
    ds_add_u32 v17, v16 offset:3248
    s_mov_b64 exec, s[46:47]
    v_mov_b32 v17, 0
L_spin2:
    ds_read_b32 v16, v17 offset:3248
    s_waitcnt lgkmcnt(0)
    v_readfirstlane_b32 s48, v16
    s_cmp_lt_u32 s48, 8
    s_cbranch_scc1 L_spin2
    ds_read_b128 v[68:71], v17 offset:2816
    ds_read_b128 v[72:75], v17 offset:2832
    ds_read_b128 v[76:79], v17 offset:2848
    ds_read_b128 v[80:83], v17 offset:2864
    s_waitcnt lgkmcnt(0)
    v_max3_f32 v66, v68, v70, v72
    v_max3_f32 v64, v74, v76, v78
    v_max3_f32 v66, v66, v80, v82
    v_max_f32 v66, v66, v64
    v_max3_f32 v67, v69, v71, v73
    v_max3_f32 v65, v75, v77, v79
    v_max3_f32 v67, v67, v81, v83
    v_max_f32 v67, v67, v65
    v_sub_f32 v48, v48, v66
    v_sub_f32 v49, v49, v67
    v_sub_f32 v50, v50, v66
    v_sub_f32 v51, v51, v67
    v_sub_f32 v52, v52, v66
    v_sub_f32 v53, v53, v67
    v_sub_f32 v54, v54, v66
    v_sub_f32 v55, v55, v67
    v_sub_f32 v56, v56, v66
    v_sub_f32 v57, v57, v67
    v_sub_f32 v58, v58, v66
    v_sub_f32 v59, v59, v67
    v_sub_f32 v60, v60, v66
    v_sub_f32 v61, v61, v67
    v_sub_f32 v62, v62, v66
    v_sub_f32 v63, v63, v67
    v_exp_f32 v48, v48
    v_exp_f32 v49, v49
    v_exp_f32 v50, v50
    v_exp_f32 v51, v51
    v_exp_f32 v52, v52
    v_exp_f32 v53, v53
    v_exp_f32 v54, v54
    v_exp_f32 v55, v55
    v_exp_f32 v56, v56
    v_exp_f32 v57, v57
    v_exp_f32 v58, v58
    v_exp_f32 v59, v59
    v_exp_f32 v60, v60
    v_exp_f32 v61, v61
    v_exp_f32 v62, v62
    v_exp_f32 v63, v63
    s_nop 0
    v_add_f32 v64, v48, v50
    v_add_f32 v64, v64, v52
    v_add_f32 v64, v64, v54
    v_add_f32 v64, v64, v56
    v_add_f32 v64, v64, v58
    v_add_f32 v64, v64, v60
    v_add_f32 v64, v64, v62
    v_add_f32 v65, v49, v51
    v_add_f32 v65, v65, v53
    v_add_f32 v65, v65, v55
    v_add_f32 v65, v65, v57
    v_add_f32 v65, v65, v59
    v_add_f32 v65, v65, v61
    v_add_f32 v65, v65, v63
    s_nop 1
    v_permlane32_swap_b32 v64, v65
    v_add_f32 v64, v64, v65
    v_mov_b32 v65, v64
    s_nop 1
    v_permlane16_swap_b32 v64, v65
    v_add_f32 v64, v64, v65
    s_lshl_b32 s48, s28, 3
    v_lshrrev_b32 v17, 5, v2
    v_lshl_add_u32 v17, v17, 2, s48
    s_mov_b64 s[46:47], exec
    s_mov_b32 exec_lo, 1
    s_mov_b32 exec_hi, 1
    ds_write_b32 v17, v64 offset:2880
    s_mov_b64 exec, s[46:47]
    s_waitcnt vmcnt(12)
    v_lshlrev_b32 v44, 16, v116
    v_and_b32 v45, 0xffff0000, v116
    v_pk_mul_f32 v[28:29], v[44:45], v[48:49] op_sel:[0,0] op_sel_hi:[1,0]
    v_pk_mul_f32 v[36:37], v[44:45], v[48:49] op_sel:[0,1] op_sel_hi:[1,1]
    v_lshlrev_b32 v44, 16, v117
    v_and_b32 v45, 0xffff0000, v117
    v_pk_mul_f32 v[30:31], v[44:45], v[48:49] op_sel:[0,0] op_sel_hi:[1,0]
    v_pk_mul_f32 v[38:39], v[44:45], v[48:49] op_sel:[0,1] op_sel_hi:[1,1]
    v_lshlrev_b32 v44, 16, v118
    v_and_b32 v45, 0xffff0000, v118
    v_pk_mul_f32 v[32:33], v[44:45], v[48:49] op_sel:[0,0] op_sel_hi:[1,0]
    v_pk_mul_f32 v[40:41], v[44:45], v[48:49] op_sel:[0,1] op_sel_hi:[1,1]
    v_lshlrev_b32 v44, 16, v119
    v_and_b32 v45, 0xffff0000, v119
    v_pk_mul_f32 v[34:35], v[44:45], v[48:49] op_sel:[0,0] op_sel_hi:[1,0]
    v_pk_mul_f32 v[42:43], v[44:45], v[48:49] op_sel:[0,1] op_sel_hi:[1,1]
    s_waitcnt vmcnt(11)
    v_lshlrev_b32 v44, 16, v120
    v_and_b32 v45, 0xffff0000, v120
    v_pk_fma_f32 v[28:29], v[44:45], v[50:51], v[28:29] op_sel:[0,0,0] op_sel_hi:[1,0,1]
    v_pk_fma_f32 v[36:37], v[44:45], v[50:51], v[36:37] op_sel:[0,1,0] op_sel_hi:[1,1,1]
    v_lshlrev_b32 v44, 16, v121
    v_and_b32 v45, 0xffff0000, v121
    v_pk_fma_f32 v[30:31], v[44:45], v[50:51], v[30:31] op_sel:[0,0,0] op_sel_hi:[1,0,1]
    v_pk_fma_f32 v[38:39], v[44:45], v[50:51], v[38:39] op_sel:[0,1,0] op_sel_hi:[1,1,1]
    v_lshlrev_b32 v44, 16, v122
    v_and_b32 v45, 0xffff0000, v122
    v_pk_fma_f32 v[32:33], v[44:45], v[50:51], v[32:33] op_sel:[0,0,0] op_sel_hi:[1,0,1]
    v_pk_fma_f32 v[40:41], v[44:45], v[50:51], v[40:41] op_sel:[0,1,0] op_sel_hi:[1,1,1]
    v_lshlrev_b32 v44, 16, v123
    v_and_b32 v45, 0xffff0000, v123
    v_pk_fma_f32 v[34:35], v[44:45], v[50:51], v[34:35] op_sel:[0,0,0] op_sel_hi:[1,0,1]
    v_pk_fma_f32 v[42:43], v[44:45], v[50:51], v[42:43] op_sel:[0,1,0] op_sel_hi:[1,1,1]
    s_waitcnt vmcnt(10)
    v_lshlrev_b32 v44, 16, v124
    v_and_b32 v45, 0xffff0000, v124
    v_pk_fma_f32 v[28:29], v[44:45], v[52:53], v[28:29] op_sel:[0,0,0] op_sel_hi:[1,0,1]
    v_pk_fma_f32 v[36:37], v[44:45], v[52:53], v[36:37] op_sel:[0,1,0] op_sel_hi:[1,1,1]
    v_lshlrev_b32 v44, 16, v125
    v_and_b32 v45, 0xffff0000, v125
    v_pk_fma_f32 v[30:31], v[44:45], v[52:53], v[30:31] op_sel:[0,0,0] op_sel_hi:[1,0,1]
    v_pk_fma_f32 v[38:39], v[44:45], v[52:53], v[38:39] op_sel:[0,1,0] op_sel_hi:[1,1,1]
    v_lshlrev_b32 v44, 16, v126
    v_and_b32 v45, 0xffff0000, v126
    v_pk_fma_f32 v[32:33], v[44:45], v[52:53], v[32:33] op_sel:[0,0,0] op_sel_hi:[1,0,1]
    v_pk_fma_f32 v[40:41], v[44:45], v[52:53], v[40:41] op_sel:[0,1,0] op_sel_hi:[1,1,1]
    v_lshlrev_b32 v44, 16, v127
    v_and_b32 v45, 0xffff0000, v127
    v_pk_fma_f32 v[34:35], v[44:45], v[52:53], v[34:35] op_sel:[0,0,0] op_sel_hi:[1,0,1]
    v_pk_fma_f32 v[42:43], v[44:45], v[52:53], v[42:43] op_sel:[0,1,0] op_sel_hi:[1,1,1]
    s_waitcnt vmcnt(9)
    v_lshlrev_b32 v44, 16, v128
    v_and_b32 v45, 0xffff0000, v128
    v_pk_fma_f32 v[28:29], v[44:45], v[54:55], v[28:29] op_sel:[0,0,0] op_sel_hi:[1,0,1]
    v_pk_fma_f32 v[36:37], v[44:45], v[54:55], v[36:37] op_sel:[0,1,0] op_sel_hi:[1,1,1]
    v_lshlrev_b32 v44, 16, v129
    v_and_b32 v45, 0xffff0000, v129
    v_pk_fma_f32 v[30:31], v[44:45], v[54:55], v[30:31] op_sel:[0,0,0] op_sel_hi:[1,0,1]
    v_pk_fma_f32 v[38:39], v[44:45], v[54:55], v[38:39] op_sel:[0,1,0] op_sel_hi:[1,1,1]
    v_lshlrev_b32 v44, 16, v130
    v_and_b32 v45, 0xffff0000, v130
    v_pk_fma_f32 v[32:33], v[44:45], v[54:55], v[32:33] op_sel:[0,0,0] op_sel_hi:[1,0,1]
    v_pk_fma_f32 v[40:41], v[44:45], v[54:55], v[40:41] op_sel:[0,1,0] op_sel_hi:[1,1,1]
    v_lshlrev_b32 v44, 16, v131
    v_and_b32 v45, 0xffff0000, v131
    v_pk_fma_f32 v[34:35], v[44:45], v[54:55], v[34:35] op_sel:[0,0,0] op_sel_hi:[1,0,1]
    v_pk_fma_f32 v[42:43], v[44:45], v[54:55], v[42:43] op_sel:[0,1,0] op_sel_hi:[1,1,1]
    s_waitcnt vmcnt(8)
    v_lshlrev_b32 v44, 16, v132
    v_and_b32 v45, 0xffff0000, v132
    v_pk_fma_f32 v[28:29], v[44:45], v[56:57], v[28:29] op_sel:[0,0,0] op_sel_hi:[1,0,1]
    v_pk_fma_f32 v[36:37], v[44:45], v[56:57], v[36:37] op_sel:[0,1,0] op_sel_hi:[1,1,1]
    v_lshlrev_b32 v44, 16, v133
    v_and_b32 v45, 0xffff0000, v133
    v_pk_fma_f32 v[30:31], v[44:45], v[56:57], v[30:31] op_sel:[0,0,0] op_sel_hi:[1,0,1]
    v_pk_fma_f32 v[38:39], v[44:45], v[56:57], v[38:39] op_sel:[0,1,0] op_sel_hi:[1,1,1]
    v_lshlrev_b32 v44, 16, v134
    v_and_b32 v45, 0xffff0000, v134
    v_pk_fma_f32 v[32:33], v[44:45], v[56:57], v[32:33] op_sel:[0,0,0] op_sel_hi:[1,0,1]
    v_pk_fma_f32 v[40:41], v[44:45], v[56:57], v[40:41] op_sel:[0,1,0] op_sel_hi:[1,1,1]
    v_lshlrev_b32 v44, 16, v135
    v_and_b32 v45, 0xffff0000, v135
    v_pk_fma_f32 v[34:35], v[44:45], v[56:57], v[34:35] op_sel:[0,0,0] op_sel_hi:[1,0,1]
    v_pk_fma_f32 v[42:43], v[44:45], v[56:57], v[42:43] op_sel:[0,1,0] op_sel_hi:[1,1,1]
    s_waitcnt vmcnt(7)
    v_lshlrev_b32 v44, 16, v136
    v_and_b32 v45, 0xffff0000, v136
    v_pk_fma_f32 v[28:29], v[44:45], v[58:59], v[28:29] op_sel:[0,0,0] op_sel_hi:[1,0,1]
    v_pk_fma_f32 v[36:37], v[44:45], v[58:59], v[36:37] op_sel:[0,1,0] op_sel_hi:[1,1,1]
    v_lshlrev_b32 v44, 16, v137
    v_and_b32 v45, 0xffff0000, v137
    v_pk_fma_f32 v[30:31], v[44:45], v[58:59], v[30:31] op_sel:[0,0,0] op_sel_hi:[1,0,1]
    v_pk_fma_f32 v[38:39], v[44:45], v[58:59], v[38:39] op_sel:[0,1,0] op_sel_hi:[1,1,1]
    v_lshlrev_b32 v44, 16, v138
    v_and_b32 v45, 0xffff0000, v138
    v_pk_fma_f32 v[32:33], v[44:45], v[58:59], v[32:33] op_sel:[0,0,0] op_sel_hi:[1,0,1]
    v_pk_fma_f32 v[40:41], v[44:45], v[58:59], v[40:41] op_sel:[0,1,0] op_sel_hi:[1,1,1]
    v_lshlrev_b32 v44, 16, v139
    v_and_b32 v45, 0xffff0000, v139
    v_pk_fma_f32 v[34:35], v[44:45], v[58:59], v[34:35] op_sel:[0,0,0] op_sel_hi:[1,0,1]
    v_pk_fma_f32 v[42:43], v[44:45], v[58:59], v[42:43] op_sel:[0,1,0] op_sel_hi:[1,1,1]
    s_waitcnt vmcnt(6)
    v_lshlrev_b32 v44, 16, v140
    v_and_b32 v45, 0xffff0000, v140
    v_pk_fma_f32 v[28:29], v[44:45], v[60:61], v[28:29] op_sel:[0,0,0] op_sel_hi:[1,0,1]
    v_pk_fma_f32 v[36:37], v[44:45], v[60:61], v[36:37] op_sel:[0,1,0] op_sel_hi:[1,1,1]
    v_lshlrev_b32 v44, 16, v141
    v_and_b32 v45, 0xffff0000, v141
    v_pk_fma_f32 v[30:31], v[44:45], v[60:61], v[30:31] op_sel:[0,0,0] op_sel_hi:[1,0,1]
    v_pk_fma_f32 v[38:39], v[44:45], v[60:61], v[38:39] op_sel:[0,1,0] op_sel_hi:[1,1,1]
    v_lshlrev_b32 v44, 16, v142
    v_and_b32 v45, 0xffff0000, v142
    v_pk_fma_f32 v[32:33], v[44:45], v[60:61], v[32:33] op_sel:[0,0,0] op_sel_hi:[1,0,1]
    v_pk_fma_f32 v[40:41], v[44:45], v[60:61], v[40:41] op_sel:[0,1,0] op_sel_hi:[1,1,1]
    v_lshlrev_b32 v44, 16, v143
    v_and_b32 v45, 0xffff0000, v143
    v_pk_fma_f32 v[34:35], v[44:45], v[60:61], v[34:35] op_sel:[0,0,0] op_sel_hi:[1,0,1]
    v_pk_fma_f32 v[42:43], v[44:45], v[60:61], v[42:43] op_sel:[0,1,0] op_sel_hi:[1,1,1]
    s_waitcnt vmcnt(5)
    v_lshlrev_b32 v44, 16, v144
    v_and_b32 v45, 0xffff0000, v144
    v_pk_fma_f32 v[28:29], v[44:45], v[62:63], v[28:29] op_sel:[0,0,0] op_sel_hi:[1,0,1]
    v_pk_fma_f32 v[36:37], v[44:45], v[62:63], v[36:37] op_sel:[0,1,0] op_sel_hi:[1,1,1]
    v_lshlrev_b32 v44, 16, v145
    v_and_b32 v45, 0xffff0000, v145
    v_pk_fma_f32 v[30:31], v[44:45], v[62:63], v[30:31] op_sel:[0,0,0] op_sel_hi:[1,0,1]
    v_pk_fma_f32 v[38:39], v[44:45], v[62:63], v[38:39] op_sel:[0,1,0] op_sel_hi:[1,1,1]
    v_lshlrev_b32 v44, 16, v146
    v_and_b32 v45, 0xffff0000, v146
    v_pk_fma_f32 v[32:33], v[44:45], v[62:63], v[32:33] op_sel:[0,0,0] op_sel_hi:[1,0,1]
    v_pk_fma_f32 v[40:41], v[44:45], v[62:63], v[40:41] op_sel:[0,1,0] op_sel_hi:[1,1,1]
    v_lshlrev_b32 v44, 16, v147
    v_and_b32 v45, 0xffff0000, v147
    v_pk_fma_f32 v[34:35], v[44:45], v[62:63], v[34:35] op_sel:[0,0,0] op_sel_hi:[1,0,1]
    v_pk_fma_f32 v[42:43], v[44:45], v[62:63], v[42:43] op_sel:[0,1,0] op_sel_hi:[1,1,1]
    s_nop 1
    v_permlane32_swap_b32 v28, v36
    v_permlane32_swap_b32 v29, v37
    v_permlane32_swap_b32 v30, v38
    v_permlane32_swap_b32 v31, v39
    v_permlane32_swap_b32 v32, v40
    v_permlane32_swap_b32 v33, v41
    v_permlane32_swap_b32 v34, v42
    v_permlane32_swap_b32 v35, v43
    v_add_f32 v28, v28, v36
    v_add_f32 v29, v29, v37
    v_add_f32 v30, v30, v38
    v_add_f32 v31, v31, v39
    v_add_f32 v32, v32, v40
    v_add_f32 v33, v33, v41
    v_add_f32 v34, v34, v42
    v_add_f32 v35, v35, v43
    s_nop 1
    v_permlane16_swap_b32 v28, v32
    v_permlane16_swap_b32 v29, v33
    v_permlane16_swap_b32 v30, v34
    v_permlane16_swap_b32 v31, v35
    v_add_f32 v28, v28, v32
    v_add_f32 v29, v29, v33
    v_add_f32 v30, v30, v34
    v_add_f32 v31, v31, v35
    v_and_b32 v3, 15, v2
    v_lshlrev_b32 v3, 5, v3
    v_bfe_u32 v4, v2, 4, 1
    v_lshl_add_u32 v3, v4, 4, v3
    v_lshrrev_b32 v4, 5, v2
    v_lshl_add_u32 v3, v4, 9, v3
    s_lshl_b32 s48, s28, 10
    v_add_u32 v3, s48, v3
    ds_write_b128 v3, v[28:31] offset:7424
    s_waitcnt lgkmcnt(0)
    s_barrier
    s_barrier
    ds_read_b32 v8, v1 offset:2944
    ds_read_b32 v9, v1 offset:2972
    ds_read_b32 v10, v1 offset:3000
    ds_read_b32 v11, v1 offset:3028
    ds_read_b32 v12, v1 offset:3056
    s_waitcnt lgkmcnt(0)
    s_waitcnt vmcnt(4)
    v_lshlrev_b32 v44, 16, v148
    v_and_b32 v45, 0xffff0000, v148
    v_mul_f32 v28, v44, v8
    v_mul_f32 v29, v45, v8
    v_lshlrev_b32 v44, 16, v149
    v_and_b32 v45, 0xffff0000, v149
    v_mul_f32 v30, v44, v8
    v_mul_f32 v31, v45, v8
    v_lshlrev_b32 v44, 16, v150
    v_and_b32 v45, 0xffff0000, v150
    v_mul_f32 v32, v44, v8
    v_mul_f32 v33, v45, v8
    v_lshlrev_b32 v44, 16, v151
    v_and_b32 v45, 0xffff0000, v151
    v_mul_f32 v34, v44, v8
    v_mul_f32 v35, v45, v8
    s_waitcnt vmcnt(3)
    v_lshlrev_b32 v44, 16, v152
    v_and_b32 v45, 0xffff0000, v152
    v_fmac_f32 v28, v44, v9
    v_fmac_f32 v29, v45, v9
    v_lshlrev_b32 v44, 16, v153
    v_and_b32 v45, 0xffff0000, v153
    v_fmac_f32 v30, v44, v9
    v_fmac_f32 v31, v45, v9
    v_lshlrev_b32 v44, 16, v154
    v_and_b32 v45, 0xffff0000, v154
    v_fmac_f32 v32, v44, v9
    v_fmac_f32 v33, v45, v9
    v_lshlrev_b32 v44, 16, v155
    v_and_b32 v45, 0xffff0000, v155
    v_fmac_f32 v34, v44, v9
    v_fmac_f32 v35, v45, v9
    s_waitcnt vmcnt(2)
    v_lshlrev_b32 v44, 16, v156
    v_and_b32 v45, 0xffff0000, v156
    v_fmac_f32 v28, v44, v10
    v_fmac_f32 v29, v45, v10
    v_lshlrev_b32 v44, 16, v157
    v_and_b32 v45, 0xffff0000, v157
    v_fmac_f32 v30, v44, v10
    v_fmac_f32 v31, v45, v10
    v_lshlrev_b32 v44, 16, v158
    v_and_b32 v45, 0xffff0000, v158
    v_fmac_f32 v32, v44, v10
    v_fmac_f32 v33, v45, v10
    v_lshlrev_b32 v44, 16, v159
    v_and_b32 v45, 0xffff0000, v159
    v_fmac_f32 v34, v44, v10
    v_fmac_f32 v35, v45, v10
    s_waitcnt vmcnt(1)
    v_lshlrev_b32 v44, 16, v160
    v_and_b32 v45, 0xffff0000, v160
    v_fmac_f32 v28, v44, v11
    v_fmac_f32 v29, v45, v11
    v_lshlrev_b32 v44, 16, v161
    v_and_b32 v45, 0xffff0000, v161
    v_fmac_f32 v30, v44, v11
    v_fmac_f32 v31, v45, v11
    v_lshlrev_b32 v44, 16, v162
    v_and_b32 v45, 0xffff0000, v162
    v_fmac_f32 v32, v44, v11
    v_fmac_f32 v33, v45, v11
    v_lshlrev_b32 v44, 16, v163
    v_and_b32 v45, 0xffff0000, v163
    v_fmac_f32 v34, v44, v11
    v_fmac_f32 v35, v45, v11
    s_waitcnt vmcnt(0)
    v_lshlrev_b32 v44, 16, v164
    v_and_b32 v45, 0xffff0000, v164
    v_fmac_f32 v28, v44, v12
    v_fmac_f32 v29, v45, v12
    v_lshlrev_b32 v44, 16, v165
    v_and_b32 v45, 0xffff0000, v165
    v_fmac_f32 v30, v44, v12
    v_fmac_f32 v31, v45, v12
    v_lshlrev_b32 v44, 16, v166
    v_and_b32 v45, 0xffff0000, v166
    v_fmac_f32 v32, v44, v12
    v_fmac_f32 v33, v45, v12
    v_lshlrev_b32 v44, 16, v167
    v_and_b32 v45, 0xffff0000, v167
    v_fmac_f32 v34, v44, v12
    v_fmac_f32 v35, v45, v12
    s_movk_i32 s49, 504
    v_cmp_gt_u32 vcc, s49, v0
    s_and_saveexec_b64 s[46:47], vcc
    s_cbranch_execz L_skipC
    ds_write_b128 v47, v[28:31] offset:7424
    ds_write_b128 v47, v[32:35] offset:7440
L_skipC:
    s_mov_b64 exec, s[46:47]
    s_waitcnt lgkmcnt(0)
    s_barrier
    s_cmp_ge_u32 s28, 3
    s_cbranch_scc1 L_skipC2
    v_mov_b32 v17, 0
    ds_read_b32 v67, v17 offset:3256
    v_mul_u32_u24 v8, 12, v0
    ds_read_b32 v72, v8 offset:7424
    ds_read_b32 v73, v8 offset:7428
    ds_read_b32 v74, v8 offset:7432
    ds_read_b32 v76, v8 offset:9728
    ds_read_b32 v77, v8 offset:9732
    ds_read_b32 v78, v8 offset:9736
    ds_read_b32 v80, v8 offset:12032
    ds_read_b32 v81, v8 offset:12036
    ds_read_b32 v82, v8 offset:12040
    ds_read_b32 v84, v8 offset:14336
    ds_read_b32 v85, v8 offset:14340
    ds_read_b32 v86, v8 offset:14344
    ds_read_b32 v88, v8 offset:16640
    ds_read_b32 v89, v8 offset:16644
    ds_read_b32 v90, v8 offset:16648
    ds_read_b32 v92, v8 offset:18944
    ds_read_b32 v93, v8 offset:18948
    ds_read_b32 v94, v8 offset:18952
    ds_read_b32 v96, v8 offset:21248
    ds_read_b32 v97, v8 offset:21252
    ds_read_b32 v98, v8 offset:21256
    s_mul_i32 s48, s2, 3072
    s_add_u32 s48, s48, 1310720
    s_add_u32 s50, s26, s48
    s_addc_u32 s51, s27, 0
    v_lshlrev_b32 v4, 4, v0
    s_waitcnt lgkmcnt(0)
    v_add_f32 v64, v72, v76
    v_add_f32 v64, v64, v80
    v_add_f32 v64, v64, v84
    v_add_f32 v64, v64, v88
    v_add_f32 v64, v64, v92
    v_add_f32 v64, v64, v96
    v_add_f32 v65, v73, v77
    v_add_f32 v65, v65, v81
    v_add_f32 v65, v65, v85
    v_add_f32 v65, v65, v89
    v_add_f32 v65, v65, v93
    v_add_f32 v65, v65, v97
    v_add_f32 v66, v74, v78
    v_add_f32 v66, v66, v82
    v_add_f32 v66, v66, v86
    v_add_f32 v66, v66, v90
    v_add_f32 v66, v66, v94
    v_add_f32 v66, v66, v98
    global_store_dwordx4 v4, v[64:67], s[50:51] sc0 sc1
L_skipC2:
    s_endpgm
L_comm:
    s_memrealtime s[74:75]
    v_mov_b32 v4, 0
    v_mov_b32 v5, 0
    v_mov_b32 v6, 0
    v_mov_b32 v7, 0
    v_lshlrev_b32 v3, 4, v2
    v_cmp_gt_u32 vcc, 20, v2
    s_and_saveexec_b64 s[46:47], vcc
    ds_write_b128 v3, v[4:7] offset:2944
    s_mov_b64 exec, s[46:47]
    s_waitcnt lgkmcnt(0)
    s_or_b32 s74, s74, 1
    v_mov_b32 v8, s74
    s_mov_b64 s[46:47], exec
    s_mov_b64 exec, 1
    s_cmp_lg_u32 s2, 0
    s_cbranch_scc1 L_npoll
    global_store_dword v4, v8, s[24:25] sc0 sc1
    v_mov_b32 v10, v8
    s_branch L_ndone
L_npoll:
    s_mov_b32 s70, 0
L_np:
    global_load_dword v10, v4, s[24:25] sc0 sc1
    s_waitcnt vmcnt(0)
    v_readfirstlane_b32 s71, v10
    s_cmp_lg_u32 s71, 0
    s_cbranch_scc1 L_ndone
    s_add_u32 s70, s70, 1
    s_cmp_lt_u32 s70, 0x100000
    s_cbranch_scc1 L_np
L_ndone:
    s_nop 0
    v_readfirstlane_b32 s74, v10
    s_mov_b64 exec, s[46:47]
    v_mov_b32 v63, s74
    v_mov_b32 v5, 0
    ds_write_b32 v5, v63 offset:3256
    s_waitcnt lgkmcnt(0)
    v_add_u32 v4, 0, v2
    v_min_u32 v4, 87, v4
    v_mul_u32_u24 v5, 745, v4
    v_lshrrev_b32 v5, 14, v5
    v_mul_u32_u24 v6, 22, v5
    v_sub_u32 v6, v4, v6
    s_lshl_b32 s48, s29, 2
    v_add_u32 v7, s48, v5
    v_mul_u32_u24 v10, 1408, v7
    v_lshl_add_u32 v10, v6, 4, v10
    v_mov_b32 v28, v5
    v_mov_b32 v29, v6
    v_add_u32 v20, 0, v10
    v_add_u32 v21, 352, v10
    v_add_u32 v22, 704, v10
    v_add_u32 v23, 1056, v10
    v_add_u32 v4, 64, v2
    v_min_u32 v4, 87, v4
    v_mul_u32_u24 v5, 745, v4
    v_lshrrev_b32 v5, 14, v5
    v_mul_u32_u24 v6, 22, v5
    v_sub_u32 v6, v4, v6
    s_lshl_b32 s48, s29, 2
    v_add_u32 v7, s48, v5
    v_mul_u32_u24 v10, 1408, v7
    v_lshl_add_u32 v10, v6, 4, v10
    v_mov_b32 v30, v5
    v_mov_b32 v31, v6
    v_add_u32 v24, 0, v10
    v_add_u32 v25, 352, v10
    v_add_u32 v26, 704, v10
    v_add_u32 v27, 1056, v10
    s_barrier
    s_mov_b32 s70, 0
L_g0:
    global_load_dwordx4 v[64:67], v20, s[26:27] sc0 sc1
    global_load_dwordx4 v[68:71], v21, s[26:27] sc0 sc1
    global_load_dwordx4 v[72:75], v22, s[26:27] sc0 sc1
    global_load_dwordx4 v[76:79], v23, s[26:27] sc0 sc1
    global_load_dwordx4 v[80:83], v24, s[26:27] sc0 sc1
    global_load_dwordx4 v[84:87], v25, s[26:27] sc0 sc1
    global_load_dwordx4 v[88:91], v26, s[26:27] sc0 sc1
    global_load_dwordx4 v[92:95], v27, s[26:27] sc0 sc1
    s_waitcnt vmcnt(0)
    v_xor_b32 v62, v63, v67
    v_xor_b32 v61, v63, v71
    v_or_b32 v62, v62, v61
    v_xor_b32 v61, v63, v75
    v_or_b32 v62, v62, v61
    v_xor_b32 v61, v63, v79
    v_or_b32 v62, v62, v61
    v_xor_b32 v61, v63, v83
    v_or_b32 v62, v62, v61
    v_xor_b32 v61, v63, v87
    v_or_b32 v62, v62, v61
    v_xor_b32 v61, v63, v91
    v_or_b32 v62, v62, v61
    v_xor_b32 v61, v63, v95
    v_or_b32 v62, v62, v61
    v_cmp_ne_u32 vcc, 0, v62
    s_cbranch_vccz L_gd0
    s_sleep 1
    s_add_u32 s70, s70, 1
    s_cmp_lt_u32 s70, 0x100000
    s_cbranch_scc1 L_g0
L_gd0:
    v_add_f32 v64, v64, v68
    v_add_f32 v65, v65, v69
    v_add_f32 v66, v66, v70
    v_add_f32 v64, v64, v72
    v_add_f32 v65, v65, v73
    v_add_f32 v66, v66, v74
    v_add_f32 v64, v64, v76
    v_add_f32 v65, v65, v77
    v_add_f32 v66, v66, v78
    v_cvt_pk_bf16_f32 v64, v64, v64
    v_cvt_pk_bf16_f32 v65, v65, v65
    v_cvt_pk_bf16_f32 v66, v66, v66
    v_mul_u32_u24 v6, 3, v29
    v_lshl_add_u32 v7, v28, 6, v6
    v_lshlrev_b32 v7, 1, v7
    ds_write_b16 v7, v64 offset:2304
    v_cmp_gt_u32 vcc, 63, v6
    s_and_saveexec_b64 s[46:47], vcc
    ds_write_b16 v7, v65 offset:2306
    ds_write_b16 v7, v66 offset:2308
    s_mov_b64 exec, s[46:47]
    v_add_f32 v80, v80, v84
    v_add_f32 v81, v81, v85
    v_add_f32 v82, v82, v86
    v_add_f32 v80, v80, v88
    v_add_f32 v81, v81, v89
    v_add_f32 v82, v82, v90
    v_add_f32 v80, v80, v92
    v_add_f32 v81, v81, v93
    v_add_f32 v82, v82, v94
    v_cvt_pk_bf16_f32 v64, v80, v80
    v_cvt_pk_bf16_f32 v65, v81, v81
    v_cvt_pk_bf16_f32 v66, v82, v82
    v_mul_u32_u24 v6, 3, v31
    v_lshl_add_u32 v7, v30, 6, v6
    v_lshlrev_b32 v7, 1, v7
    ds_write_b16 v7, v64 offset:2304
    v_cmp_gt_u32 vcc, 63, v6
    s_and_saveexec_b64 s[46:47], vcc
    ds_write_b16 v7, v65 offset:2306
    ds_write_b16 v7, v66 offset:2308
    s_mov_b64 exec, s[46:47]
    s_waitcnt lgkmcnt(0)
    s_barrier
    s_lshr_b32 s48, s2, 3
    s_and_b32 s48, s48, 1
    s_mul_i32 s48, s48, 768
    s_and_b32 s49, s2, 7
    s_mul_i32 s49, s49, 96
    s_add_u32 s48, s48, s49
    s_mul_i32 s49, s29, 16*1536
    s_add_u32 s48, s48, s49
    s_add_u32 s48, s48, 917504
    v_add_u32 v4, 0, v2
    v_min_u32 v4, 95, v4
    v_mul_u32_u24 v5, 171, v4
    v_lshrrev_b32 v5, 10, v5
    v_mul_u32_u24 v6, 6, v5
    v_sub_u32 v6, v4, v6
    v_mul_u32_u24 v20, 1536, v5
    v_lshl_add_u32 v20, v6, 4, v20
    v_add_u32 v20, s48, v20
    v_mul_u32_u24 v6, 12, v6
    v_mul_u32_u24 v7, 80, v5
    v_add_u32 v22, v6, v7
    v_add_u32 v4, 64, v2
    v_min_u32 v4, 95, v4
    v_mul_u32_u24 v5, 171, v4
    v_lshrrev_b32 v5, 10, v5
    v_mul_u32_u24 v6, 6, v5
    v_sub_u32 v6, v4, v6
    v_mul_u32_u24 v21, 1536, v5
    v_lshl_add_u32 v21, v6, 4, v21
    v_add_u32 v21, s48, v21
    v_mul_u32_u24 v6, 12, v6
    v_mul_u32_u24 v7, 80, v5
    v_add_u32 v23, v6, v7
    s_mul_i32 s48, s2, 18
    v_and_b32 v4, 31, v2
    v_min_u32 v4, 17, v4
    v_add_u32 v4, s48, v4
    v_lshrrev_b32 v5, 6, v4
    v_and_b32 v6, 63, v4
    v_lshrrev_b32 v7, 5, v2
    v_mul_u32_u24 v7, 72, v7
    v_add_u32 v7, v7, v5
    v_mul_u32_u24 v8, 57, v7
    v_lshrrev_b32 v8, 9, v8
    v_mul_u32_u24 v9, 9, v8
    v_sub_u32 v9, v7, v9
    v_mul_u32_u24 v10, 50688, v8
    v_mul_u32_u24 v9, 352, v9
    v_add_u32 v10, v10, v9
    v_mul_u32_u24 v11, 21846, v6
    v_lshrrev_b32 v11, 16, v11
    v_lshl_add_u32 v10, v11, 4, v10
    v_mul_u32_u24 v11, 3, v11
    v_sub_u32 v44, v6, v11
    v_add_u32 v24, 98304, v10
    v_add_u32 v25, 101472, v10
    v_add_u32 v26, 104640, v10
    v_add_u32 v27, 107808, v10
    v_add_u32 v28, 110976, v10
    v_add_u32 v29, 114144, v10
    v_add_u32 v30, 117312, v10
    v_add_u32 v31, 120480, v10
    v_add_u32 v32, 123648, v10
    v_add_u32 v33, 126816, v10
    v_add_u32 v34, 129984, v10
    v_add_u32 v35, 133152, v10
    v_add_u32 v36, 136320, v10
    v_add_u32 v37, 139488, v10
    v_add_u32 v38, 142656, v10
    v_add_u32 v39, 145824, v10
    s_mov_b32 s70, 0
L_g1:
    global_load_dwordx4 v[80:83], v24, s[26:27] sc0 sc1
    global_load_dwordx4 v[84:87], v25, s[26:27] sc0 sc1
    global_load_dwordx4 v[88:91], v26, s[26:27] sc0 sc1
    global_load_dwordx4 v[92:95], v27, s[26:27] sc0 sc1
    global_load_dwordx4 v[96:99], v28, s[26:27] sc0 sc1
    global_load_dwordx4 v[100:103], v29, s[26:27] sc0 sc1
    global_load_dwordx4 v[104:107], v30, s[26:27] sc0 sc1
    global_load_dwordx4 v[108:111], v31, s[26:27] sc0 sc1
    global_load_dwordx4 v[112:115], v32, s[26:27] sc0 sc1
    global_load_dwordx4 v[116:119], v33, s[26:27] sc0 sc1
    global_load_dwordx4 v[120:123], v34, s[26:27] sc0 sc1
    global_load_dwordx4 v[124:127], v35, s[26:27] sc0 sc1
    global_load_dwordx4 v[128:131], v36, s[26:27] sc0 sc1
    global_load_dwordx4 v[132:135], v37, s[26:27] sc0 sc1
    global_load_dwordx4 v[136:139], v38, s[26:27] sc0 sc1
    global_load_dwordx4 v[140:143], v39, s[26:27] sc0 sc1
    s_waitcnt vmcnt(0)
    v_xor_b32 v62, v63, v83
    v_xor_b32 v61, v63, v87
    v_or_b32 v62, v62, v61
    v_xor_b32 v61, v63, v91
    v_or_b32 v62, v62, v61
    v_xor_b32 v61, v63, v95
    v_or_b32 v62, v62, v61
    v_xor_b32 v61, v63, v99
    v_or_b32 v62, v62, v61
    v_xor_b32 v61, v63, v103
    v_or_b32 v62, v62, v61
    v_xor_b32 v61, v63, v107
    v_or_b32 v62, v62, v61
    v_xor_b32 v61, v63, v111
    v_or_b32 v62, v62, v61
    v_xor_b32 v61, v63, v115
    v_or_b32 v62, v62, v61
    v_xor_b32 v61, v63, v119
    v_or_b32 v62, v62, v61
    v_xor_b32 v61, v63, v123
    v_or_b32 v62, v62, v61
    v_xor_b32 v61, v63, v127
    v_or_b32 v62, v62, v61
    v_xor_b32 v61, v63, v131
    v_or_b32 v62, v62, v61
    v_xor_b32 v61, v63, v135
    v_or_b32 v62, v62, v61
    v_xor_b32 v61, v63, v139
    v_or_b32 v62, v62, v61
    v_xor_b32 v61, v63, v143
    v_or_b32 v62, v62, v61
    v_cmp_ne_u32 vcc, 0, v62
    s_cbranch_vccz L_gd1
    s_sleep 1
    s_add_u32 s70, s70, 1
    s_cmp_lt_u32 s70, 0x100000
    s_cbranch_scc1 L_g1
L_gd1:
    v_add_f32 v80, v80, v84
    v_add_f32 v81, v81, v85
    v_add_f32 v82, v82, v86
    v_add_f32 v80, v80, v88
    v_add_f32 v81, v81, v89
    v_add_f32 v82, v82, v90
    v_add_f32 v80, v80, v92
    v_add_f32 v81, v81, v93
    v_add_f32 v82, v82, v94
    v_add_f32 v80, v80, v96
    v_add_f32 v81, v81, v97
    v_add_f32 v82, v82, v98
    v_add_f32 v80, v80, v100
    v_add_f32 v81, v81, v101
    v_add_f32 v82, v82, v102
    v_add_f32 v80, v80, v104
    v_add_f32 v81, v81, v105
    v_add_f32 v82, v82, v106
    v_add_f32 v80, v80, v108
    v_add_f32 v81, v81, v109
    v_add_f32 v82, v82, v110
    v_add_f32 v80, v80, v112
    v_add_f32 v81, v81, v113
    v_add_f32 v82, v82, v114
    v_add_f32 v80, v80, v116
    v_add_f32 v81, v81, v117
    v_add_f32 v82, v82, v118
    v_add_f32 v80, v80, v120
    v_add_f32 v81, v81, v121
    v_add_f32 v82, v82, v122
    v_add_f32 v80, v80, v124
    v_add_f32 v81, v81, v125
    v_add_f32 v82, v82, v126
    v_add_f32 v80, v80, v128
    v_add_f32 v81, v81, v129
    v_add_f32 v82, v82, v130
    v_add_f32 v80, v80, v132
    v_add_f32 v81, v81, v133
    v_add_f32 v82, v82, v134
    v_add_f32 v80, v80, v136
    v_add_f32 v81, v81, v137
    v_add_f32 v82, v82, v138
    v_add_f32 v80, v80, v140
    v_add_f32 v81, v81, v141
    v_add_f32 v82, v82, v142
    v_cmp_eq_u32 vcc, 1, v44
    s_nop 1
    v_cndmask_b32 v80, v80, v81, vcc
    v_cmp_eq_u32 vcc, 2, v44
    s_nop 1
    v_cndmask_b32 v80, v80, v82, vcc
    v_cvt_pk_bf16_f32 v80, v80, v80
    v_lshlrev_b32 v80, 16, v80
    s_nop 1
    v_permlane32_swap_b32 v80, v81
    v_max_f32 v80, 0, v80
    v_mul_f32 v80, v80, v81
    v_cvt_pk_bf16_f32 v80, v80, v80
    v_lshlrev_b32 v80, 16, v80
    v_lshlrev_b32 v4, 2, v2
    v_cmp_gt_u32 vcc, 18, v2
    s_and_saveexec_b64 s[46:47], vcc
    ds_write_b32 v4, v80 offset:3008
    s_mov_b64 exec, s[46:47]
    s_barrier
    v_lshlrev_b32 v4, 4, v2
    ds_read_b128 v[64:67], v4 offset:7424
    ds_read_b128 v[68:71], v4 offset:8448
    ds_read_b128 v[72:75], v4 offset:9472
    ds_read_b128 v[76:79], v4 offset:10496
    ds_read_b128 v[80:83], v4 offset:11520
    ds_read_b128 v[84:87], v4 offset:12544
    ds_read_b128 v[88:91], v4 offset:13568
    ds_read_b128 v[92:95], v4 offset:14592
    v_mov_b32 v5, 0
    ds_read_b128 v[96:99], v5 offset:2816
    ds_read_b128 v[112:115], v5 offset:2880
    ds_read_b128 v[100:103], v5 offset:2832
    ds_read_b128 v[116:119], v5 offset:2896
    ds_read_b128 v[104:107], v5 offset:2848
    ds_read_b128 v[120:123], v5 offset:2912
    ds_read_b128 v[108:111], v5 offset:2864
    ds_read_b128 v[124:127], v5 offset:2928
    s_waitcnt lgkmcnt(0)
    v_add_f32 v64, v64, v68
    v_add_f32 v65, v65, v69
    v_add_f32 v66, v66, v70
    v_add_f32 v67, v67, v71
    v_add_f32 v64, v64, v72
    v_add_f32 v65, v65, v73
    v_add_f32 v66, v66, v74
    v_add_f32 v67, v67, v75
    v_add_f32 v64, v64, v76
    v_add_f32 v65, v65, v77
    v_add_f32 v66, v66, v78
    v_add_f32 v67, v67, v79
    v_add_f32 v64, v64, v80
    v_add_f32 v65, v65, v81
    v_add_f32 v66, v66, v82
    v_add_f32 v67, v67, v83
    v_add_f32 v64, v64, v84
    v_add_f32 v65, v65, v85
    v_add_f32 v66, v66, v86
    v_add_f32 v67, v67, v87
    v_add_f32 v64, v64, v88
    v_add_f32 v65, v65, v89
    v_add_f32 v66, v66, v90
    v_add_f32 v67, v67, v91
    v_add_f32 v64, v64, v92
    v_add_f32 v65, v65, v93
    v_add_f32 v66, v66, v94
    v_add_f32 v67, v67, v95
    v_max_f32 v16, v96, v98
    v_add_f32 v17, v112, v114
    v_max_f32 v16, v16, v100
    v_add_f32 v17, v17, v116
    v_max_f32 v16, v16, v102
    v_add_f32 v17, v17, v118
    v_max_f32 v16, v16, v104
    v_add_f32 v17, v17, v120
    v_max_f32 v16, v16, v106
    v_add_f32 v17, v17, v122
    v_max_f32 v16, v16, v108
    v_add_f32 v17, v17, v124
    v_max_f32 v16, v16, v110
    v_add_f32 v17, v17, v126
    v_max_f32 v18, v97, v99
    v_add_f32 v19, v113, v115
    v_max_f32 v18, v18, v101
    v_add_f32 v19, v19, v117
    v_max_f32 v18, v18, v103
    v_add_f32 v19, v19, v119
    v_max_f32 v18, v18, v105
    v_add_f32 v19, v19, v121
    v_max_f32 v18, v18, v107
    v_add_f32 v19, v19, v123
    v_max_f32 v18, v18, v109
    v_add_f32 v19, v19, v125
    v_max_f32 v18, v18, v111
    v_add_f32 v19, v19, v127
    v_cmp_le_u32 vcc, 32, v2
    s_nop 1
    v_cndmask_b32 v16, v16, v18, vcc
    v_cndmask_b32 v17, v17, v19, vcc
    v_lshrrev_b32 v6, 5, v2
    v_mul_u32_u24 v6, 640, v6
    v_bfe_u32 v7, v2, 2, 3
    v_mul_u32_u24 v7, 80, v7
    v_add_u32 v6, v6, v7
    v_and_b32 v7, 3, v2
    v_lshl_add_u32 v8, v7, 4, v6
    ds_write_b128 v8, v[64:67] offset:3264
    ds_write_b64 v6, v[16:17] offset:3328
    s_waitcnt lgkmcnt(0)
    s_mul_i32 s48, s2, 1536
    s_add_u32 s48, s48, 917504
    s_add_u32 s50, s26, s48
    s_addc_u32 s51, s27, 0
    v_add_u32 v4, 0, v2
    v_min_u32 v4, 95, v4
    v_mul_u32_u24 v5, 171, v4
    v_lshrrev_b32 v5, 10, v5
    v_mul_u32_u24 v6, 6, v5
    v_sub_u32 v6, v4, v6
    v_mul_u32_u24 v6, 12, v6
    v_mul_u32_u24 v7, 80, v5
    v_add_u32 v6, v6, v7
    ds_read_b32 v8, v6 offset:3264
    ds_read_b32 v9, v6 offset:3268
    ds_read_b32 v10, v6 offset:3272
    v_mov_b32 v11, v63
    v_lshlrev_b32 v16, 4, v4
    v_add_u32 v4, 64, v2
    v_min_u32 v4, 95, v4
    v_mul_u32_u24 v5, 171, v4
    v_lshrrev_b32 v5, 10, v5
    v_mul_u32_u24 v6, 6, v5
    v_sub_u32 v6, v4, v6
    v_mul_u32_u24 v6, 12, v6
    v_mul_u32_u24 v7, 80, v5
    v_add_u32 v6, v6, v7
    ds_read_b32 v12, v6 offset:3264
    ds_read_b32 v13, v6 offset:3268
    ds_read_b32 v14, v6 offset:3272
    v_mov_b32 v15, v63
    v_lshlrev_b32 v17, 4, v4
    s_waitcnt lgkmcnt(0)
    global_store_dwordx4 v16, v[8:11], s[50:51] sc0 sc1
    global_store_dwordx4 v17, v[12:15], s[50:51] sc0 sc1
    s_mov_b32 s70, 0
L_g2:
    global_load_dwordx4 v[64:67], v20, s[26:27] sc0 sc1
    global_load_dwordx4 v[68:71], v21, s[26:27] sc0 sc1
    s_waitcnt vmcnt(0)
    v_xor_b32 v62, v63, v67
    v_xor_b32 v61, v63, v71
    v_or_b32 v62, v62, v61
    v_cmp_ne_u32 vcc, 0, v62
    s_cbranch_vccz L_gd2
    s_sleep 1
    s_add_u32 s70, s70, 1
    s_cmp_lt_u32 s70, 0x100000
    s_cbranch_scc1 L_g2
L_gd2:
    ds_write_b32 v22, v64 offset:4608
    ds_write_b32 v22, v65 offset:4612
    ds_write_b32 v22, v66 offset:4616
    ds_write_b32 v23, v68 offset:4608
    ds_write_b32 v23, v69 offset:4612
    ds_write_b32 v23, v70 offset:4616
    s_waitcnt lgkmcnt(0)
    v_lshrrev_b32 v4, 2, v2
    v_mul_u32_u24 v4, 80, v4
    ds_read_b64 v[12:13], v4 offset:4672
    v_and_b32 v5, 3, v2
    v_lshl_add_u32 v4, v5, 4, v4
    ds_read_b128 v[8:11], v4 offset:4608
    s_waitcnt lgkmcnt(0)
    v_mov_b32 v14, v12
    s_nop 1
    v_max_f32_dpp v14, v14, v14 row_ror:8 row_mask:0xf bank_mask:0xf
    s_nop 1
    v_max_f32_dpp v14, v14, v14 row_ror:4 row_mask:0xf bank_mask:0xf
    s_nop 1
    v_readlane_b32 s64, v14, 0
    v_readlane_b32 s65, v14, 16
    v_readlane_b32 s66, v14, 32
    v_readlane_b32 s67, v14, 48
    s_nop 1
    v_mov_b32 v14, s64
    v_max_f32 v14, s65, v14
    v_max_f32 v14, s66, v14
    v_max_f32 v14, s67, v14
    v_sub_f32 v14, v12, v14
    v_exp_f32 v14, v14
    s_nop 0
    v_mul_f32 v15, v14, v13
    s_nop 1
    v_add_f32_dpp v15, v15, v15 row_ror:8 row_mask:0xf bank_mask:0xf
    s_nop 1
    v_add_f32_dpp v15, v15, v15 row_ror:4 row_mask:0xf bank_mask:0xf
    s_nop 1
    v_readlane_b32 s64, v15, 0
    v_readlane_b32 s65, v15, 16
    v_readlane_b32 s66, v15, 32
    v_readlane_b32 s67, v15, 48
    s_nop 1
    v_mov_b32 v15, s64
    v_add_f32 v15, s65, v15
    v_add_f32 v15, s66, v15
    v_add_f32 v15, s67, v15
    v_mul_f32 v8, v8, v14
    v_mul_f32 v9, v9, v14
    v_mul_f32 v10, v10, v14
    v_mul_f32 v11, v11, v14
    s_nop 1
    v_add_f32_dpp v8, v8, v8 row_ror:8 row_mask:0xf bank_mask:0xf
    s_nop 1
    v_add_f32_dpp v8, v8, v8 row_ror:4 row_mask:0xf bank_mask:0xf
    s_nop 1
    v_add_f32_dpp v9, v9, v9 row_ror:8 row_mask:0xf bank_mask:0xf
    s_nop 1
    v_add_f32_dpp v9, v9, v9 row_ror:4 row_mask:0xf bank_mask:0xf
    s_nop 1
    v_add_f32_dpp v10, v10, v10 row_ror:8 row_mask:0xf bank_mask:0xf
    s_nop 1
    v_add_f32_dpp v10, v10, v10 row_ror:4 row_mask:0xf bank_mask:0xf
    s_nop 1
    v_add_f32_dpp v11, v11, v11 row_ror:8 row_mask:0xf bank_mask:0xf
    s_nop 1
    v_add_f32_dpp v11, v11, v11 row_ror:4 row_mask:0xf bank_mask:0xf
    v_lshrrev_b32 v6, 4, v2
    v_lshlrev_b32 v6, 6, v6
    v_lshl_add_u32 v6, v5, 4, v6
    v_and_b32 v7, 12, v2
    v_cmp_eq_u32 vcc, 0, v7
    s_and_saveexec_b64 s[46:47], vcc
    ds_write_b128 v6, v[8:11] offset:3264
    s_mov_b64 exec, s[46:47]
    s_waitcnt lgkmcnt(0)
    v_lshlrev_b32 v5, 4, v5
    ds_read_b128 v[64:67], v5 offset:3264
    ds_read_b128 v[68:71], v5 offset:3328
    ds_read_b128 v[72:75], v5 offset:3392
    ds_read_b128 v[76:79], v5 offset:3456
    v_rcp_f32 v15, v15
    s_waitcnt lgkmcnt(0)
    v_add_f32 v64, v64, v68
    v_add_f32 v72, v72, v76
    v_add_f32 v64, v64, v72
    v_mul_f32 v64, v64, v15
    v_cvt_pk_bf16_f32 v64, v64, v64
    v_lshlrev_b32 v64, 16, v64
    v_add_f32 v65, v65, v69
    v_add_f32 v73, v73, v77
    v_add_f32 v65, v65, v73
    v_mul_f32 v65, v65, v15
    v_cvt_pk_bf16_f32 v65, v65, v65
    v_lshlrev_b32 v65, 16, v65
    v_add_f32 v66, v66, v70
    v_add_f32 v74, v74, v78
    v_add_f32 v66, v66, v74
    v_mul_f32 v66, v66, v15
    v_cvt_pk_bf16_f32 v66, v66, v66
    v_lshlrev_b32 v66, 16, v66
    v_add_f32 v67, v67, v71
    v_add_f32 v75, v75, v79
    v_add_f32 v67, v67, v75
    v_mul_f32 v67, v67, v15
    v_cvt_pk_bf16_f32 v67, v67, v67
    v_lshlrev_b32 v67, 16, v67
    v_cmp_gt_u32 vcc, 4, v2
    s_and_saveexec_b64 s[46:47], vcc
    ds_write_b128 v5, v[64:67] offset:2944
    s_mov_b64 exec, s[46:47]
    s_waitcnt lgkmcnt(0)
    s_barrier
    s_cmp_ge_u32 s2, 192
    s_cbranch_scc1 L_fin0
    s_lshl_b32 s48, s2, 4
    s_add_u32 s48, s48, 1310720
    v_mul_u32_u24 v4, 3072, v2
    v_add_u32 v20, s48, v4
    v_add_u32 v4, 196608, v4
    v_add_u32 v21, s48, v4
    v_add_u32 v4, 196608, v4
    v_add_u32 v22, s48, v4
    v_add_u32 v4, 196608, v4
    v_add_u32 v23, s48, v4
    s_mul_i32 s48, s2, 6
    v_min_u32 v7, 2, v2
    v_lshlrev_b32 v7, 1, v7
    v_add_u32 v7, s48, v7
    buffer_load_ushort v12, v7, s[36:39], 0 offen
L_fin0:
    s_barrier
    s_cmp_ge_u32 s2, 192
    s_cbranch_scc1 L_end2
    s_mov_b32 s70, 0
L_g3:
    global_load_dwordx4 v[64:67], v20, s[26:27] sc0 sc1
    global_load_dwordx4 v[68:71], v21, s[26:27] sc0 sc1
    global_load_dwordx4 v[72:75], v22, s[26:27] sc0 sc1
    global_load_dwordx4 v[76:79], v23, s[26:27] sc0 sc1
    s_waitcnt vmcnt(0)
    v_xor_b32 v62, v63, v67
    v_xor_b32 v61, v63, v71
    v_or_b32 v62, v62, v61
    v_xor_b32 v61, v63, v75
    v_or_b32 v62, v62, v61
    v_xor_b32 v61, v63, v79
    v_or_b32 v62, v62, v61
    v_cmp_ne_u32 vcc, 0, v62
    s_cbranch_vccz L_gd3
    s_sleep 1
    s_add_u32 s70, s70, 1
    s_cmp_lt_u32 s70, 0x100000
    s_cbranch_scc1 L_g3
L_gd3:
    v_add_f32 v64, v64, v68
    v_add_f32 v65, v65, v69
    v_add_f32 v66, v66, v70
    v_add_f32 v64, v64, v72
    v_add_f32 v65, v65, v73
    v_add_f32 v66, v66, v74
    v_add_f32 v64, v64, v76
    v_add_f32 v65, v65, v77
    v_add_f32 v66, v66, v78
    s_nop 1
    v_add_f32_dpp v64, v64, v64 row_ror:8 row_mask:0xf bank_mask:0xf
    v_add_f32_dpp v65, v65, v65 row_ror:8 row_mask:0xf bank_mask:0xf
    v_add_f32_dpp v66, v66, v66 row_ror:8 row_mask:0xf bank_mask:0xf
    s_nop 1
    v_add_f32_dpp v64, v64, v64 row_ror:4 row_mask:0xf bank_mask:0xf
    v_add_f32_dpp v65, v65, v65 row_ror:4 row_mask:0xf bank_mask:0xf
    v_add_f32_dpp v66, v66, v66 row_ror:4 row_mask:0xf bank_mask:0xf
    s_nop 1
    v_add_f32_dpp v64, v64, v64 row_ror:2 row_mask:0xf bank_mask:0xf
    v_add_f32_dpp v65, v65, v65 row_ror:2 row_mask:0xf bank_mask:0xf
    v_add_f32_dpp v66, v66, v66 row_ror:2 row_mask:0xf bank_mask:0xf
    s_nop 1
    v_add_f32_dpp v64, v64, v64 row_ror:1 row_mask:0xf bank_mask:0xf
    v_add_f32_dpp v65, v65, v65 row_ror:1 row_mask:0xf bank_mask:0xf
    v_add_f32_dpp v66, v66, v66 row_ror:1 row_mask:0xf bank_mask:0xf
    s_nop 1
    v_readlane_b32 s64, v64, 0
    v_readlane_b32 s65, v64, 16
    v_readlane_b32 s66, v64, 32
    v_readlane_b32 s67, v64, 48
    s_nop 1
    v_mov_b32 v64, s64
    v_add_f32 v64, s65, v64
    v_add_f32 v64, s66, v64
    v_add_f32 v64, s67, v64
    s_nop 1
    v_readlane_b32 s64, v65, 0
    v_readlane_b32 s65, v65, 16
    v_readlane_b32 s66, v65, 32
    v_readlane_b32 s67, v65, 48
    s_nop 1
    v_mov_b32 v65, s64
    v_add_f32 v65, s65, v65
    v_add_f32 v65, s66, v65
    v_add_f32 v65, s67, v65
    s_nop 1
    v_readlane_b32 s64, v66, 0
    v_readlane_b32 s65, v66, 16
    v_readlane_b32 s66, v66, 32
    v_readlane_b32 s67, v66, 48
    s_nop 1
    v_mov_b32 v66, s64
    v_add_f32 v66, s65, v66
    v_add_f32 v66, s66, v66
    v_add_f32 v66, s67, v66
    v_cmp_eq_u32 vcc, 1, v2
    s_nop 1
    v_cndmask_b32 v64, v64, v65, vcc
    v_cmp_eq_u32 vcc, 2, v2
    s_nop 1
    v_cndmask_b32 v64, v64, v66, vcc
    v_lshlrev_b32 v12, 16, v12
    v_add_f32 v64, v64, v12
    v_cvt_pk_bf16_f32 v65, v64, v64
    s_mov_b32 s56, s22
    s_and_b32 s57, s23, 0xffff
    s_movk_i32 s58, 1152
    s_mov_b32 s59, 0x20000
    v_cmp_gt_u32 vcc, 3, v2
    s_and_saveexec_b64 s[46:47], vcc
    buffer_store_short v65, v7, s[56:59], 0 offen
    s_mov_b64 exec, s[46:47]
L_end2:
L_end:
    s_endpgm
.section .rodata,"a"
.p2align 6
.amdhsa_kernel parallel_sum__sliding_block_cached__glu_gated_reglu__decode_kernel
  .amdhsa_next_free_vgpr 168
  .amdhsa_next_free_sgpr 96
  .amdhsa_accum_offset 168
  .amdhsa_group_segment_fixed_size 0
  .amdhsa_kernarg_size 96
  .amdhsa_user_sgpr_count 2
  .amdhsa_user_sgpr_kernarg_segment_ptr 1
  .amdhsa_system_sgpr_workgroup_id_x 1
.end_amdhsa_kernel
```
